```python
import torch

def _softmax(x, axis=-1):
    return torch.softmax(x, dim=axis)
def _gelu(x):
    return torch.nn.functional.gelu(x, approximate="tanh")
def _silu(x):
    return torch.nn.functional.silu(x)
def _sigmoid(x):
    return torch.sigmoid(x)
def _layernorm(x, axis=-1, eps=1e-5):
    m = x.mean(dim=axis, keepdim=True)
    v = x.var(dim=axis, keepdim=True, unbiased=False)
    return (x - m) / torch.sqrt(v + eps)
def _scatter_add(tgt, idx, src, axis=0):
    return tgt.clone().index_add_(axis, idx, src)
def _segment_sum(src, seg, n):
    out = torch.zeros((n,) + src.shape[1:], dtype=src.dtype)
    return out.index_add_(0, seg, src)
def _pad(x, pw):
    flat = tuple(v for pair in reversed(pw) for v in pair)
    return torch.nn.functional.pad(x, flat)

kernel_name = 'gather_scatter__edge_featured_mpnn_egc__graph'

def setup_inputs():

    _w = (lambda a: (lambda t: t.to(torch.bfloat16) if t.is_floating_point() else t)(torch.as_tensor(a)))
    N, deg, D, De = 50000, 16, 64, max(16, 1)
    E = N * deg
    return {
        "x": _w((lambda *s: torch.randn(*s, dtype=torch.bfloat16) * 0.2)(N, D)),
        "e_attr": _w((lambda *s: torch.randn(*s, dtype=torch.bfloat16) * 0.2)(E, De)),
        "src": _w((lambda lo, hi, *s: torch.randint(lo, hi, s))(0, N, E).to(torch.int64)),
        "dst": _w((lambda lo, hi, *s: torch.randint(lo, hi, s))(0, N, E).to(torch.int64)),
        "u_w": _w((lambda *s: torch.randn(*s, dtype=torch.bfloat16) * 0.05)(D, D)),
        "v_w": _w((lambda *s: torch.randn(*s, dtype=torch.bfloat16) * 0.05)(D, D)),
        "g_w": _w((lambda *s: torch.randn(*s, dtype=torch.bfloat16) * 0.2)(2 * D + De, D)),
    }

def reference(x, e_attr, src, dst, u_w, v_w, g_w):
    N, D = x.shape
    g_in = torch.concatenate([x[dst], x[src], e_attr], axis=-1)
    eta = _sigmoid(g_in @ g_w)
    hv = x @ v_w
    msg = eta * hv[src]
    agg = _segment_sum(msg, dst, N)
    return _silu(x @ u_w + agg)
```

```asm
; @launch kernel=gather_scatter__edge_featured_mpnn_egc__graph_kernel grid=(256,1,1) block=(512,1,1) lds=163840
.amdgcn_target "amdgcn-amd-amdhsa--gfx950"
.text
    .globl gather_scatter__edge_featured_mpnn_egc__graph_kernel
    .p2align 8
    .type gather_scatter__edge_featured_mpnn_egc__graph_kernel,@function
gather_scatter__edge_featured_mpnn_egc__graph_kernel:
    s_load_dwordx8 s[40:47], s[0:1], 0
    s_load_dwordx2 s[56:57], s[0:1], 72
    s_load_dwordx8 s[48:55], s[0:1], 32
    s_cmp_ge_u32 s2, 256
    s_cbranch_scc1 K2_END
    s_getpc_b64 s[4:5]
K2_PC:
    v_lshlrev_b32 v254, 6, v0
    v_mov_b32 v255, s5
    v_min_u32 v254, K2_LAST-K2_PC-4, v254
    v_add_co_u32 v254, vcc, s4, v254
    v_addc_co_u32 v255, vcc, 0, v255, vcc
    global_load_dword v255, v[254:255], off
    v_lshrrev_b32 v248, 6, v0
    v_and_b32 v239, 63, v0
    v_readfirstlane_b32 s3, v248
    v_lshlrev_b32 v249, 4, v0
    s_lshl_b32 s58, s2, 3
    v_lshl_add_u32 v250, v0, 1, s58
    v_and_b32 v232, 62, v250
    v_mov_b32 v233, 0
    v_xor_b32 v234, 32, v232
    v_mov_b32 v235, 0
    v_add_u32 v236, 33792, v249
    ds_write_b128 v236, v[232:235] offset:0
    ds_write_b128 v236, v[232:235] offset:8192
    ds_write_b128 v236, v[232:235] offset:16384
    ds_write_b128 v236, v[232:235] offset:24576
    v_mul_u32_u24 v251, 12, v239
    v_lshlrev_b32 v250, 2, v239
    s_mul_i32 s58, s2, 12500
    s_mul_i32 s59, s3, 1564
    s_add_u32 s58, s58, s59
    s_mov_b32 s98, 3200000
    s_mov_b32 s99, 0x20000
    s_mov_b32 s18, 3200000
    s_mov_b32 s19, 0x20000
    v_add_u32 v237, 99328, v249
    v_mov_b32 v64, 0
    v_mov_b32 v65, 0
    v_mov_b32 v66, 0
    v_mov_b32 v67, 0
    v_lshlrev_b32 v243, 4, v239
    s_waitcnt lgkmcnt(0)
    s_mov_b32 s96, s46
    s_and_b32 s97, s47, 0xffff
    buffer_load_dwordx3 v[104:106], v251, s[96:99], s58 offen nt
    buffer_load_dwordx3 v[108:110], v251, s[96:99], s58 offen offset:768 nt
    buffer_load_dword v112, v250, s[96:99], s58 offen offset:1536 nt
    s_mov_b32 s16, s44
    s_and_b32 s17, s45, 0xffff
    buffer_load_dwordx3 v[114:116], v251, s[16:19], s58 offen nt
    buffer_load_dwordx3 v[118:120], v251, s[16:19], s58 offen offset:768 nt
    buffer_load_dword v122, v250, s[16:19], s58 offen offset:1536 nt
    s_load_dword s94, s[56:57], 0
    ds_write_b128 v243, v[64:67] offset:32768
    ds_write_b128 v236, v[232:235] offset:32768
    ds_write_b128 v236, v[232:235] offset:40960
    ds_write_b128 v236, v[232:235] offset:49152
    ds_write_b128 v236, v[232:235] offset:57344
    ds_write_b128 v237, v[232:235]
    s_mov_b32 s8, s40
    s_and_b32 s9, s41, 0xffff
    s_mov_b32 s10, 6400000
    s_mov_b32 s11, 0x20000
    s_mov_b32 s4, s42
    s_and_b32 s5, s43, 0xffff
    s_mov_b32 s6, 25600000
    s_mov_b32 s7, 0x20000
    s_mov_b32 s12, s56
    s_and_b32 s13, s57, 0xffff
    s_mov_b32 s14, 268435456
    s_mov_b32 s15, 0x20000
    s_mov_b32 s20, s54
    s_and_b32 s21, s55, 0xffff
    s_mov_b32 s23, 0x20000
    s_mov_b32 s40, s52
    s_and_b32 s41, s53, 0xffff
    s_movk_i32 s42, 18432
    s_mov_b32 s43, 0x20000
    s_lshl_b32 s24, s3, 11
    s_cmp_lt_u32 s3, 5
    s_cselect_b32 s48, s50, s48
    s_cselect_b32 s49, s51, s49
    s_cselect_b32 s56, 1, 5
    s_sub_u32 s32, s3, s56
    s_movk_i32 s50, 8192
    s_cmp_eq_u32 s3, 0
    s_cselect_b32 s48, s52, s48
    s_cselect_b32 s49, s53, s49
    s_cselect_b32 s32, 8, s32
    s_cselect_b32 s50, s42, s50
    s_lshl_b32 s32, s32, 11
    s_and_b32 s49, s49, 0xffff
    s_mov_b32 s51, 0x20000
    s_add_u32 m0, s24, 129024
    s_cmp_lg_u32 s3, 7
    buffer_load_dwordx4 v243, s[40:43], s24 offen lds
    buffer_load_dwordx4 v243, s[40:43], s24 offen offset:1024 lds
    s_add_u32 m0, s24, 145408
    s_cmp_lg_u32 s3, 7
    buffer_load_dwordx4 v243, s[48:51], s32 offen lds
    buffer_load_dwordx4 v243, s[48:51], s32 offen offset:1024 lds
    s_cbranch_scc1 K2_W3
    buffer_load_dwordx4 v243, s[48:51], s32 offen offset:2048 lds
    buffer_load_dwordx4 v243, s[48:51], s32 offen offset:3072 lds
K2_W3:
    s_mov_b32 s33, 175921861
    s_movk_i32 s95, 3125
    s_cmp_eq_u32 s3, 7
    s_cselect_b32 s100, 15, 0x7f
    s_mov_b32 s101, 0
    s_mul_i32 s59, s3, 391
    v_mov_b32 v133, 1
    v_mov_b32 v134, 127
    s_mov_b32 s28, 0
    s_mov_b32 s52, 1342
    s_mov_b32 s54, 0x800000
    s_movk_i32 s55, 68
    s_waitcnt lgkmcnt(0)
    s_barrier
    s_add_u32 s94, s94, 0x9e377000
    s_and_b32 s94, s94, 0xfffff000
    v_mad_u32_u24 v141, v239, 3, s59
    v_add_u32 v153, s59, v239
    v_add_u32 v143, 1, v141
    v_add_u32 v145, 2, v141
    v_add_u32 v147, 192, v141
    v_add_u32 v149, 193, v141
    v_add_u32 v151, 194, v141
    v_add_u32 v153, 384, v153
    v_lshrrev_b32 v250, 3, v0
    v_and_b32 v252, 0x70, v249
    v_lshlrev_b32 v136, 2, v250
    v_mul_u32_u24 v137, 32896, v250
    v_add_u32 v137, v137, v252
    s_lshr_b32 s57, s2, 6
    s_lshl_b32 s57, s57, 5
    v_subrev_u32 v252, s57, v249
    v_and_b32 v252, 0x70, v252
    v_mul_u32_u24 v135, 272, v250
    v_add3_u32 v135, v135, v252, v236
    v_sub_u32 v135, v135, v249
    v_lshrrev_b32 v138, 3, v252
    v_add_u32 v138, 16, v138
    s_lshl_b32 s57, s2, 7
    s_add_u32 s57, s57, 4096
    s_and_b32 s34, s2, 7
    s_lshl_b32 s34, s34, 5
    s_lshr_b32 s22, s2, 3
    s_or_b32 s34, s34, s22
    s_lshl_b32 s38, s34, 3
    s_add_u32 s38, s38, s3
    s_mul_i32 s38, s38, 3125
    s_add_u32 s22, s38, 3252
    s_add_u32 s38, s38, 127
    s_and_b32 s38, s38, -128
    s_and_b32 s22, s22, -128
    v_lshrrev_b32 v5, 4, v239
    v_xor_b32 v5, v5, v239
    v_and_b32 v5, 7, v5
    v_lshlrev_b32 v5, 4, v5
    v_xor_b32 v6, 64, v5
    v_lshrrev_b32 v245, 3, v239
    s_lshl_b32 s27, s3, 12
    s_add_u32 s26, s27, 0x8000
    v_lshl_add_u32 v244, v245, 8, v5
    v_xor_b32 v245, 0xc0, v244
    ds_write_b128 v237, v[64:67] offset:10752
    ds_write_b128 v237, v[64:67] offset:18944
    s_cmp_ge_u32 s3, 2
    s_cbranch_scc1 K2_Z
    ds_write_b128 v237, v[64:67] offset:27136
K2_Z:
    s_cmp_lg_u32 s3, 2
    s_cbranch_scc1 K2_Z2
    v_cmp_lt_u32 vcc, 31, v239
    v_mul_u32_u24 v253, 696, v239
    v_add_u32 v253, 43264, v253
    v_bfrev_b32 v250, 2
    v_cndmask_b32 v250, v250, v253, vcc
    v_lshlrev_b32 v252, 2, v239
    v_add_u32 v252, 128512, v252
    ds_write2st64_b32 v252, v250, v250 offset0:0 offset1:1
K2_Z2:
    s_mov_b32 m0, s27
    s_nop 0
    buffer_load_dwordx4 v244, s[8:11], s38 offen offset:0 lds
    buffer_load_dwordx4 v244, s[8:11], s38 offen offset:2048 lds
    s_add_u32 m0, m0, 1024
    s_nop 0
    buffer_load_dwordx4 v245, s[8:11], s38 offen offset:0 lds
    buffer_load_dwordx4 v245, s[8:11], s38 offen offset:2048 lds
    s_waitcnt vmcnt(13)
    v_mul_hi_u32 v124, v104, s33
    v_lshrrev_b32 v161, 1, v124
    v_and_b32 v161, 0x3fc, v161
    ds_add_rtn_u32 v154, v161, v133 offset:32768
    v_mul_hi_u32 v125, v105, s33
    v_lshrrev_b32 v162, 1, v125
    v_and_b32 v162, 0x3fc, v162
    ds_add_rtn_u32 v155, v162, v133 offset:32768
    v_mul_hi_u32 v126, v106, s33
    v_lshrrev_b32 v163, 1, v126
    v_and_b32 v163, 0x3fc, v163
    ds_add_rtn_u32 v156, v163, v133 offset:32768
    s_waitcnt vmcnt(12)
    v_mul_hi_u32 v127, v108, s33
    v_lshrrev_b32 v164, 1, v127
    v_and_b32 v164, 0x3fc, v164
    ds_add_rtn_u32 v157, v164, v133 offset:32768
    v_mul_hi_u32 v128, v109, s33
    v_lshrrev_b32 v165, 1, v128
    v_and_b32 v165, 0x3fc, v165
    ds_add_rtn_u32 v158, v165, v133 offset:32768
    v_mul_hi_u32 v129, v110, s33
    v_lshrrev_b32 v166, 1, v129
    v_and_b32 v166, 0x3fc, v166
    ds_add_rtn_u32 v159, v166, v133 offset:32768
    s_waitcnt vmcnt(11)
    v_mul_hi_u32 v130, v112, s33
    v_lshrrev_b32 v167, 1, v130
    v_and_b32 v167, 0x3fc, v167
    s_mov_b64 exec, s[100:101]
    ds_add_rtn_u32 v160, v167, v133 offset:32768
    s_mov_b64 exec, -1
    v_mad_u32_u24 v131, v124, s95, v134
    v_lshrrev_b32 v131, 7, v131
    v_sub_u32 v131, v104, v131
    v_and_b32 v132, 7, v124
    v_lshl_or_b32 v132, v132, 3, 64
    v_lshl_or_b32 v140, v131, 27, v132
    v_and_b32 v104, 1792, v124
    v_mul_i32_i24 v104, 0xffff8000, v104
    v_mul_u32_u24 v161, s55, v161
    v_mad_u32_u24 v131, v125, s95, v134
    v_lshrrev_b32 v131, 7, v131
    v_sub_u32 v131, v105, v131
    v_and_b32 v132, 7, v125
    v_lshl_or_b32 v132, v132, 3, 64
    v_lshl_or_b32 v142, v131, 27, v132
    v_and_b32 v105, 1792, v125
    v_mul_i32_i24 v105, 0xffff8000, v105
    v_mul_u32_u24 v162, s55, v162
    v_mad_u32_u24 v131, v126, s95, v134
    v_lshrrev_b32 v131, 7, v131
    v_sub_u32 v131, v106, v131
    v_and_b32 v132, 7, v126
    v_lshl_or_b32 v132, v132, 3, 64
    v_lshl_or_b32 v144, v131, 27, v132
    v_and_b32 v106, 1792, v126
    v_mul_i32_i24 v106, 0xffff8000, v106
    v_mul_u32_u24 v163, s55, v163
    v_mad_u32_u24 v131, v127, s95, v134
    v_lshrrev_b32 v131, 7, v131
    v_sub_u32 v131, v108, v131
    v_and_b32 v132, 7, v127
    v_lshl_or_b32 v132, v132, 3, 64
    v_lshl_or_b32 v146, v131, 27, v132
    v_and_b32 v108, 1792, v127
    v_mul_i32_i24 v108, 0xffff8000, v108
    v_mul_u32_u24 v164, s55, v164
    v_mad_u32_u24 v131, v128, s95, v134
    v_lshrrev_b32 v131, 7, v131
    v_sub_u32 v131, v109, v131
    v_and_b32 v132, 7, v128
    v_lshl_or_b32 v132, v132, 3, 64
    v_lshl_or_b32 v148, v131, 27, v132
    v_and_b32 v109, 1792, v128
    v_mul_i32_i24 v109, 0xffff8000, v109
    v_mul_u32_u24 v165, s55, v165
    v_mad_u32_u24 v131, v129, s95, v134
    v_lshrrev_b32 v131, 7, v131
    v_sub_u32 v131, v110, v131
    v_and_b32 v132, 7, v129
    v_lshl_or_b32 v132, v132, 3, 64
    v_lshl_or_b32 v150, v131, 27, v132
    v_and_b32 v110, 1792, v129
    v_mul_i32_i24 v110, 0xffff8000, v110
    v_mul_u32_u24 v166, s55, v166
    v_mad_u32_u24 v131, v130, s95, v134
    v_lshrrev_b32 v131, 7, v131
    v_sub_u32 v131, v112, v131
    v_and_b32 v132, 7, v130
    v_lshl_or_b32 v132, v132, 3, 64
    v_lshl_or_b32 v152, v131, 27, v132
    v_and_b32 v112, 1792, v130
    v_mul_i32_i24 v112, 0xffff8000, v112
    v_mul_u32_u24 v167, s55, v167
    s_waitcnt vmcnt(10) lgkmcnt(6)
    v_mad_u32_u24 v131, v114, s52, v104
    v_lshl_or_b32 v140, v114, 7, v140
    v_lshrrev_b32 v131, 23, v131
    v_and_or_b32 v140, v131, 6, v140
    v_min_u32 v124, 32, v154
    v_lshl_add_u32 v124, v124, 3, v161
    ds_write_b64 v124, v[140:141] offset:33792
    s_waitcnt lgkmcnt(6)
    v_mad_u32_u24 v131, v115, s52, v105
    v_lshl_or_b32 v142, v115, 7, v142
    v_lshrrev_b32 v131, 23, v131
    v_and_or_b32 v142, v131, 6, v142
    v_min_u32 v125, 32, v155
    v_lshl_add_u32 v125, v125, 3, v162
    ds_write_b64 v125, v[142:143] offset:33792
    s_waitcnt lgkmcnt(6)
    v_mad_u32_u24 v131, v116, s52, v106
    v_lshl_or_b32 v144, v116, 7, v144
    v_lshrrev_b32 v131, 23, v131
    v_and_or_b32 v144, v131, 6, v144
    v_min_u32 v126, 32, v156
    v_lshl_add_u32 v126, v126, 3, v163
    ds_write_b64 v126, v[144:145] offset:33792
    s_waitcnt vmcnt(9) lgkmcnt(6)
    v_mad_u32_u24 v131, v118, s52, v108
    v_lshl_or_b32 v146, v118, 7, v146
    v_lshrrev_b32 v131, 23, v131
    v_and_or_b32 v146, v131, 6, v146
    v_min_u32 v127, 32, v157
    v_lshl_add_u32 v127, v127, 3, v164
    ds_write_b64 v127, v[146:147] offset:33792
    s_waitcnt lgkmcnt(6)
    v_mad_u32_u24 v131, v119, s52, v109
    v_lshl_or_b32 v148, v119, 7, v148
    v_lshrrev_b32 v131, 23, v131
    v_and_or_b32 v148, v131, 6, v148
    v_min_u32 v128, 32, v158
    v_lshl_add_u32 v128, v128, 3, v165
    ds_write_b64 v128, v[148:149] offset:33792
    s_waitcnt lgkmcnt(6)
    v_mad_u32_u24 v131, v120, s52, v110
    v_lshl_or_b32 v150, v120, 7, v150
    v_lshrrev_b32 v131, 23, v131
    v_and_or_b32 v150, v131, 6, v150
    v_min_u32 v129, 32, v159
    v_lshl_add_u32 v129, v129, 3, v166
    ds_write_b64 v129, v[150:151] offset:33792
    s_waitcnt vmcnt(8) lgkmcnt(6)
    v_mad_u32_u24 v131, v122, s52, v112
    v_lshl_or_b32 v152, v122, 7, v152
    v_lshrrev_b32 v131, 23, v131
    v_and_or_b32 v152, v131, 6, v152
    v_min_u32 v130, 32, v160
    v_lshl_add_u32 v130, v130, 3, v167
    s_mov_b64 exec, s[100:101]
    ds_write_b64 v130, v[152:153] offset:33792
    s_mov_b64 exec, -1
K2_PASS:
    s_waitcnt lgkmcnt(0)
    s_barrier
    s_setprio 1
    ds_read_b32 v200, v136 offset:32768
    ds_read_b128 v[168:171], v135 offset:0
    ds_read_b32 v201, v136 offset:33024
    ds_read_b128 v[172:175], v135 offset:17408
    ds_read_b32 v202, v136 offset:33280
    ds_read_b128 v[176:179], v135 offset:34816
    ds_read_b32 v203, v136 offset:33536
    ds_read_b128 v[180:183], v135 offset:52224
    ds_read_b128 v[184:187], v135 offset:128
    ds_read_b128 v[188:191], v135 offset:17536
    ds_read_b128 v[192:195], v135 offset:34944
    ds_read_b128 v[196:199], v135 offset:52352
    ds_read_b128 v[204:207], v243 offset:32768
    s_add_u32 s56, s57, 0
    s_waitcnt lgkmcnt(11)
    v_sub_u32 v200, v138, v200
    v_or_b32 v169, s94, v169
    v_or_b32 v171, s94, v171
    v_and_or_b32 v168, v200, s54, v168
    buffer_store_dwordx4 v[168:171], v137, s[12:15], s56 offen sc1
    s_add_u32 s56, s57, 2105344
    s_waitcnt lgkmcnt(9)
    v_sub_u32 v201, v138, v201
    v_or_b32 v173, s94, v173
    v_or_b32 v175, s94, v175
    v_and_or_b32 v172, v201, s54, v172
    buffer_store_dwordx4 v[172:175], v137, s[12:15], s56 offen sc1
    s_add_u32 s56, s57, 4210688
    s_waitcnt lgkmcnt(7)
    v_sub_u32 v202, v138, v202
    v_or_b32 v177, s94, v177
    v_or_b32 v179, s94, v179
    v_and_or_b32 v176, v202, s54, v176
    buffer_store_dwordx4 v[176:179], v137, s[12:15], s56 offen sc1
    s_add_u32 s56, s57, 6316032
    s_waitcnt lgkmcnt(5)
    v_sub_u32 v203, v138, v203
    v_or_b32 v181, s94, v181
    v_or_b32 v183, s94, v183
    v_and_or_b32 v180, v203, s54, v180
    buffer_store_dwordx4 v[180:183], v137, s[12:15], s56 offen sc1
    s_setprio 0
    s_add_u32 s44, s57, 8421376
    s_waitcnt lgkmcnt(4)
    v_or_b32 v185, s94, v185
    v_bitop3_b32 v132, v137, v200, 2.0 bitop3:0xf2
    v_add_u32 v131, 16, v200
    v_or_b32 v187, s94, v187
    v_and_or_b32 v184, v131, s54, v184
    buffer_store_dwordx4 v[184:187], v132, s[12:15], s44 offen sc1
    s_add_u32 s44, s57, 10526720
    s_waitcnt lgkmcnt(3)
    v_or_b32 v189, s94, v189
    v_bitop3_b32 v132, v137, v201, 2.0 bitop3:0xf2
    v_add_u32 v131, 16, v201
    v_or_b32 v191, s94, v191
    v_and_or_b32 v188, v131, s54, v188
    buffer_store_dwordx4 v[188:191], v132, s[12:15], s44 offen sc1
    s_add_u32 s44, s57, 12632064
    s_waitcnt lgkmcnt(2)
    v_or_b32 v193, s94, v193
    v_bitop3_b32 v132, v137, v202, 2.0 bitop3:0xf2
    v_add_u32 v131, 16, v202
    v_or_b32 v195, s94, v195
    v_and_or_b32 v192, v131, s54, v192
    buffer_store_dwordx4 v[192:195], v132, s[12:15], s44 offen sc1
    s_add_u32 s44, s57, 14737408
    s_waitcnt lgkmcnt(1)
    v_or_b32 v197, s94, v197
    v_bitop3_b32 v132, v137, v203, 2.0 bitop3:0xf2
    v_add_u32 v131, 16, v203
    v_or_b32 v199, s94, v199
    v_and_or_b32 v196, v131, s54, v196
    buffer_store_dwordx4 v[196:199], v132, s[12:15], s44 offen sc1
    s_waitcnt lgkmcnt(0)
    v_max_u32 v204, v204, v205
    v_max3_u32 v204, v204, v206, v207
    v_cmp_lt_u32 vcc, 32, v204
    s_cbranch_vccnz K2_P2
K2_P2R:
    v_and_b32 v250, 31, v239
    v_lshrrev_b32 v252, 5, v239
    s_add_u32 s47, s24, 129024
    s_add_u32 s46, s24, 145408
    s_cmp_eq_u32 s3, 0
    s_cselect_b32 s45, s46, s47
    s_cselect_b32 s46, s47, s46
    v_lshlrev_b32 v251, 2, v250
    v_lshl_add_u32 v251, v252, 10, v251
    v_add_u32 v254, s45, v251
    v_add_u32 v251, s46, v251
    s_waitcnt vmcnt(12)
    ds_read2_b32 v[24:25], v251 offset0:0 offset1:32
    ds_read2_b32 v[26:27], v251 offset0:64 offset1:96
    ds_read2_b32 v[28:29], v251 offset0:128 offset1:160
    ds_read2_b32 v[30:31], v251 offset0:192 offset1:224
    ds_read2_b32 v[16:17], v254 offset0:0 offset1:32
    ds_read2_b32 v[18:19], v254 offset0:64 offset1:96
    ds_read2_b32 v[20:21], v254 offset0:128 offset1:160
    ds_read2_b32 v[22:23], v254 offset0:192 offset1:224
    s_mov_b32 s36, 0xbfb8aa3b
    s_mov_b32 s37, s36
    s_mov_b32 s48, 0x05040100
    s_mov_b32 s49, 0x07060302
    v_add_u32 v249, s45, v243
    v_add_u32 v253, s46, v243
    v_lshlrev_b32 v196, 4, v0
    s_mul_i32 s50, s34, 32896
    s_add_u32 s50, s50, 4096
    s_add_u32 s51, s50, 8192
    s_add_u32 s52, s50, 16384
    s_add_u32 s53, s50, 24576
    s_lshr_b32 s44, 0xf1, s3
    s_bitcmp1_b32 s44, 0
    s_waitcnt lgkmcnt(4)
    v_perm_b32 v56, v25, v24, s48
    v_perm_b32 v60, v25, v24, s49
    v_perm_b32 v57, v27, v26, s48
    v_perm_b32 v61, v27, v26, s49
    v_perm_b32 v58, v29, v28, s48
    v_perm_b32 v62, v29, v28, s49
    v_perm_b32 v59, v31, v30, s48
    v_perm_b32 v63, v31, v30, s49
    ds_write_b128 v253, v[56:59] offset:0
    ds_write_b128 v253, v[60:63] offset:1024
    s_waitcnt lgkmcnt(2)
    s_cbranch_scc1 K2_WS
    v_perm_b32 v64, v17, v16, s48
    v_perm_b32 v68, v17, v16, s49
    v_perm_b32 v65, v19, v18, s48
    v_perm_b32 v69, v19, v18, s49
    v_perm_b32 v66, v21, v20, s48
    v_perm_b32 v70, v21, v20, s49
    v_perm_b32 v67, v23, v22, s48
    v_perm_b32 v71, v23, v22, s49
K2_WSR:
    ds_write_b128 v249, v[64:67] offset:0
    ds_write_b128 v249, v[68:71] offset:1024
    v_bfe_u32 v2, v250, 1, 3
    v_and_b32 v3, 1, v250
    v_and_or_b32 v2, v250, 16, v2
    v_lshl_or_b32 v2, v3, 3, v2
    v_add_u32 v248, 129024, v243
    v_bfe_u32 v253, v2, 1, 3
    v_xor_b32 v253, v253, v252
    v_lshlrev_b32 v253, 4, v253
    v_lshl_add_u32 v253, v2, 7, v253
    v_add_u32 v1, s27, v253
    v_xor_b32 v2, 32, v1
    v_xor_b32 v3, 64, v1
    v_xor_b32 v4, 0x60, v1
    v_lshlrev_b32 v9, 4, v252
    v_lshlrev_b32 v10, 10, v252
    s_lshl_b32 s45, s3, 11
    s_add_u32 s45, s45, 110080
    v_lshl_add_u32 v12, v250, 4, v10
    v_add_u32 v12, s45, v12
    v_add_u32 v10, 126464, v10
    v_bfe_u32 v253, v250, 3, 1
    v_lshlrev_b32 v11, 10, v253
    v_lshrrev_b32 v252, 4, v250
    v_lshl_add_u32 v11, v252, 9, v11
    v_and_b32 v254, 7, v250
    v_lshl_add_u32 v11, v254, 1, v11
    v_add_u32 v11, s45, v11
    v_lshlrev_b32 v238, 10, v252
    v_lshl_add_u32 v238, v250, 4, v238
    v_add_u32 v238, 126464, v238
    v_and_b32 v252, 4, v250
    v_lshlrev_b32 v253, 2, v253
    v_lshl_add_u32 v253, v252, 1, v253
    v_and_b32 v252, 3, v250
    v_lshlrev_b32 v252, v253, v252
    v_add_u32 v253, v238, v253
    v_mov_b32 v13, 0x3f80
    ds_write_b16 v238, v252 offset:14
    ds_write_b16 v253, v13
    s_waitcnt vmcnt(4) lgkmcnt(0)
    s_barrier
    buffer_load_dwordx4 v[136:139], v196, s[12:15], s50 offen sc1
    buffer_load_dwordx4 v[140:143], v196, s[12:15], s51 offen sc1
    buffer_load_dwordx4 v[144:147], v196, s[12:15], s52 offen sc1
    buffer_load_dwordx4 v[148:151], v196, s[12:15], s53 offen sc1
    ds_read_b128 v[152:155], v1 offset:0
    ds_read_b128 v[104:107], v248 offset:0
    ds_read_b128 v[156:159], v2 offset:0
    ds_read_b128 v[112:115], v248 offset:2048
    ds_read_b128 v[160:163], v3 offset:0
    ds_read_b128 v[120:123], v248 offset:4096
    ds_read_b128 v[164:167], v4 offset:0
    ds_read_b128 v[128:131], v248 offset:6144
    ds_read_b128 v[108:111], v248 offset:1024
    ds_read_b128 v[116:119], v248 offset:3072
    ds_read_b128 v[124:127], v248 offset:5120
    ds_read_b128 v[132:135], v248 offset:7168
    v_and_b32 v7, 56, v239
    v_lshlrev_b32 v255, 2, v239
    v_and_b32 v8, 0x7c, v255
    v_mov_b32 v14, 0
    s_mov_b32 s25, 0x7fff80
    s_mov_b32 s30, 1
    s_mov_b32 s35, 0x1ffffe0
    s_movk_i32 s31, 4096
    v_add_u32 v249, s27, v243
    v_lshrrev_b32 v192, 3, v0
    s_lshl_b32 s58, s94, 5
    v_mul_u32_u24 v192, 100000, v192
    v_subrev_u32 v192, s58, v192
    s_waitcnt lgkmcnt(10)
    v_mfma_f32_32x32x16_bf16 v[168:183], v[152:155], v[104:107], 0
    v_mov_b32 v198, 4
    v_mov_b32 v199, 128512
    v_lshrrev_b32 v245, 3, v239
    s_waitcnt lgkmcnt(8)
    v_mfma_f32_32x32x16_bf16 v[168:183], v[156:159], v[112:115], v[168:183]
    v_and_b32 v247, 7, v239
    v_lshl_add_u32 v244, v247, 4, v199
    v_mul_i32_i24 v245, 0xffffa901, v245
    s_waitcnt lgkmcnt(6)
    v_mfma_f32_32x32x16_bf16 v[168:183], v[160:163], v[120:123], v[168:183]
    v_mul_i32_i24 v246, 0xffffa901, v247
    v_lshlrev_b32 v247, 3, v247
    s_mov_b32 s56, 87804
    s_waitcnt lgkmcnt(4)
    v_mfma_f32_32x32x16_bf16 v[168:183], v[164:167], v[128:131], v[168:183]
    s_movk_i32 s57, 0xfff
    s_movk_i32 s40, 127
    s_sub_u32 s41, 11, s3
    s_waitcnt lgkmcnt(3)
    v_mfma_f32_32x32x16_bf16 v[208:223], v[152:155], v[108:111], 0
    s_cmp_lt_u32 s3, 4
    s_cselect_b32 s41, s3, s41
    v_add_u32 v193, 6400000, v192
    s_waitcnt lgkmcnt(2)
    v_mfma_f32_32x32x16_bf16 v[208:223], v[156:159], v[116:119], v[208:223]
    v_add_u32 v194, 12800000, v192
    v_add_u32 v195, 19200000, v192
    v_mov_b32 v236, 0xbd0677bb
    s_waitcnt lgkmcnt(1)
    v_mfma_f32_32x32x16_bf16 v[208:223], v[160:163], v[124:127], v[208:223]
    s_waitcnt lgkmcnt(0)
    v_mfma_f32_32x32x16_bf16 v[208:223], v[164:167], v[132:135], v[208:223]
    v_lshlrev_b32 v253, 1, v7
    v_add_u32 v253, 128640, v253
    v_add_u32 v251, v199, v255
    v_mul_u32_u24 v252, 696, v239
    v_add_u32 v252, 43776, v252
    v_lshrrev_b32 v254, 3, v239
    v_mul_u32_u24 v254, 11136, v254
    v_add_u32 v254, 268336, v254
    v_pk_fma_f32 v[168:169], v[168:169], s[36:37], v[236:237] op_sel_hi:[1,1,0]
    v_pk_fma_f32 v[170:171], v[170:171], s[36:37], v[236:237] op_sel_hi:[1,1,0]
    v_pk_fma_f32 v[172:173], v[172:173], s[36:37], v[236:237] op_sel_hi:[1,1,0]
    v_pk_fma_f32 v[174:175], v[174:175], s[36:37], v[236:237] op_sel_hi:[1,1,0]
    v_pk_fma_f32 v[176:177], v[176:177], s[36:37], v[236:237] op_sel_hi:[1,1,0]
    v_pk_fma_f32 v[178:179], v[178:179], s[36:37], v[236:237] op_sel_hi:[1,1,0]
    v_pk_fma_f32 v[180:181], v[180:181], s[36:37], v[236:237] op_sel_hi:[1,1,0]
    v_pk_fma_f32 v[182:183], v[182:183], s[36:37], v[236:237] op_sel_hi:[1,1,0]
    v_cvt_pk_bf16_f32 v88, v168, v169
    v_cvt_pk_bf16_f32 v89, v170, v171
    v_cvt_pk_bf16_f32 v90, v172, v173
    v_cvt_pk_bf16_f32 v91, v174, v175
    v_cvt_pk_bf16_f32 v92, v176, v177
    v_cvt_pk_bf16_f32 v93, v178, v179
    v_cvt_pk_bf16_f32 v94, v180, v181
    v_cvt_pk_bf16_f32 v95, v182, v183
    ds_write_b128 v249, v[88:91] offset:32768
    ds_write_b128 v249, v[92:95] offset:33792
    v_pk_fma_f32 v[208:209], v[208:209], s[36:37], v[236:237] op_sel_hi:[1,1,0]
    v_pk_fma_f32 v[210:211], v[210:211], s[36:37], v[236:237] op_sel_hi:[1,1,0]
    v_pk_fma_f32 v[212:213], v[212:213], s[36:37], v[236:237] op_sel_hi:[1,1,0]
    v_pk_fma_f32 v[214:215], v[214:215], s[36:37], v[236:237] op_sel_hi:[1,1,0]
    v_pk_fma_f32 v[216:217], v[216:217], s[36:37], v[236:237] op_sel_hi:[1,1,0]
    v_pk_fma_f32 v[218:219], v[218:219], s[36:37], v[236:237] op_sel_hi:[1,1,0]
    v_pk_fma_f32 v[220:221], v[220:221], s[36:37], v[236:237] op_sel_hi:[1,1,0]
    v_pk_fma_f32 v[222:223], v[222:223], s[36:37], v[236:237] op_sel_hi:[1,1,0]
    v_cvt_pk_bf16_f32 v96, v208, v209
    v_cvt_pk_bf16_f32 v97, v210, v211
    v_cvt_pk_bf16_f32 v98, v212, v213
    v_cvt_pk_bf16_f32 v99, v214, v215
    v_cvt_pk_bf16_f32 v100, v216, v217
    v_cvt_pk_bf16_f32 v101, v218, v219
    v_cvt_pk_bf16_f32 v102, v220, v221
    v_cvt_pk_bf16_f32 v103, v222, v223
    ds_write_b128 v249, v[96:99] offset:34816
    ds_write_b128 v249, v[100:103] offset:35840
    s_waitcnt vmcnt(0)
K2_PV:
    v_bitop3_b32 v104, v137, v139, s94 bitop3:0x7e
    v_bitop3_b32 v105, v141, v143, s94 bitop3:0x7e
    v_bitop3_b32 v106, v145, v147, s94 bitop3:0x7e
    v_bitop3_b32 v107, v149, v151, s94 bitop3:0x7e
    v_or3_b32 v104, v104, v105, v106
    v_or_b32 v104, v104, v107
    v_cmp_lt_u32 vcc, s57, v104
    s_cbranch_vccnz K2_PR
    s_mov_b64 exec, -1
    v_cmp_lt_u32_sdwa s[42:43], s40, v136 src0_sel:DWORD src1_sel:BYTE_2
    s_add_u32 s50, s50, 8421376
    v_cmp_lt_u32_sdwa s[44:45], s40, v140 src0_sel:DWORD src1_sel:BYTE_2
    s_add_u32 s51, s51, 8421376
    v_cmp_lt_u32_sdwa s[46:47], s40, v144 src0_sel:DWORD src1_sel:BYTE_2
    s_add_u32 s52, s52, 8421376
    v_cmp_lt_u32_sdwa s[48:49], s40, v148 src0_sel:DWORD src1_sel:BYTE_2
    s_add_u32 s53, s53, 8421376
    s_or_b64 s[100:101], s[42:43], s[44:45]
    s_and_b64 s[58:59], s[42:43], s[44:45]
    s_or_b64 s[54:55], s[46:47], s[48:49]
    s_and_b64 vcc, s[46:47], s[48:49]
    s_or_b64 s[58:59], s[58:59], vcc
    s_and_b64 vcc, s[100:101], s[54:55]
    s_or_b64 s[100:101], s[100:101], s[54:55]
    s_or_b64 s[58:59], s[58:59], vcc
    s_cbranch_scc1 K2_TG
    s_mov_b64 exec, s[42:43]
    buffer_load_dwordx4 v[152:155], v196, s[12:15], s50 offen sc1
    s_mov_b64 exec, s[44:45]
    buffer_load_dwordx4 v[152:155], v196, s[12:15], s51 offen sc1
    s_mov_b64 exec, s[46:47]
    buffer_load_dwordx4 v[152:155], v196, s[12:15], s52 offen sc1
    s_mov_b64 exec, s[48:49]
    buffer_load_dwordx4 v[152:155], v196, s[12:15], s53 offen sc1
    s_mov_b64 exec, -1
K2_TGR:
    v_bfe_u32 v104, v136, 1, 6
    v_lshl_add_u32 v104, v104, 2, v199
    ds_add_rtn_u32 v120, v104, v198
    v_bfe_u32 v105, v138, 1, 6
    v_lshl_add_u32 v105, v105, 2, v199
    ds_add_rtn_u32 v121, v105, v198
    v_bfe_u32 v106, v140, 1, 6
    v_lshl_add_u32 v106, v106, 2, v199
    ds_add_rtn_u32 v122, v106, v198
    v_bfe_u32 v107, v142, 1, 6
    v_lshl_add_u32 v107, v107, 2, v199
    ds_add_rtn_u32 v123, v107, v198
    v_bfe_u32 v108, v144, 1, 6
    v_lshl_add_u32 v108, v108, 2, v199
    ds_add_rtn_u32 v124, v108, v198
    v_bfe_u32 v109, v146, 1, 6
    v_lshl_add_u32 v109, v109, 2, v199
    ds_add_rtn_u32 v125, v109, v198
    v_bfe_u32 v110, v148, 1, 6
    v_lshl_add_u32 v110, v110, 2, v199
    ds_add_rtn_u32 v126, v110, v198
    v_bfe_u32 v111, v150, 1, 6
    v_lshl_add_u32 v111, v111, 2, v199
    ds_add_rtn_u32 v127, v111, v198
    v_lshl_add_u32 v137, v137, 5, v192
    v_lshl_add_u32 v139, v139, 5, v192
    v_lshl_add_u32 v141, v141, 5, v193
    v_lshl_add_u32 v143, v143, 5, v193
    v_lshl_add_u32 v145, v145, 5, v194
    v_lshl_add_u32 v147, v147, 5, v194
    v_lshl_add_u32 v149, v149, 5, v195
    v_lshl_add_u32 v151, v151, 5, v195
    s_movk_i32 s59, 0x46
    v_bitop3_b32 v112, v136, 64, s59 bitop3:0x28
    v_lshlrev_b32 v112, 25, v112
    v_and_or_b32 v113, v137, s35, v112
    buffer_load_dword v243, v113, s[4:7], 0 offen
    v_bitop3_b32 v114, v138, 64, s59 bitop3:0x28
    v_lshlrev_b32 v114, 25, v114
    v_and_or_b32 v115, v139, s35, v114
    buffer_load_dword v243, v115, s[4:7], 0 offen
    s_waitcnt lgkmcnt(7)
    v_min_u32 v120, s56, v120
    ds_write2st64_b32 v120, v136, v137 offset0:0 offset1:87
    s_waitcnt lgkmcnt(7)
    v_min_u32 v121, s56, v121
    ds_write2st64_b32 v121, v138, v139 offset0:0 offset1:87
    s_waitcnt lgkmcnt(7)
    v_min_u32 v122, s56, v122
    ds_write2st64_b32 v122, v140, v141 offset0:0 offset1:87
    s_waitcnt lgkmcnt(7)
    v_min_u32 v123, s56, v123
    ds_write2st64_b32 v123, v142, v143 offset0:0 offset1:87
    s_waitcnt lgkmcnt(7)
    v_min_u32 v124, s56, v124
    ds_write2st64_b32 v124, v144, v145 offset0:0 offset1:87
    s_waitcnt lgkmcnt(7)
    v_min_u32 v125, s56, v125
    ds_write2st64_b32 v125, v146, v147 offset0:0 offset1:87
    s_waitcnt lgkmcnt(7)
    v_min_u32 v126, s56, v126
    ds_write2st64_b32 v126, v148, v149 offset0:0 offset1:87
    s_waitcnt lgkmcnt(7)
    v_min_u32 v127, s56, v127
    ds_write2st64_b32 v127, v150, v151 offset0:0 offset1:87
K2_X7:
    s_waitcnt lgkmcnt(0)
    s_barrier
    ds_read_b128 v[200:203], v253
    ds_read_b128 v[204:207], v244 offset:128
    s_or_b32 s58, s2, s3
    s_cbranch_scc0 K2_EP
K2_EPR:
    s_waitcnt lgkmcnt(0)
    s_barrier
    v_add3_u32 v242, v200, v201, v202
    v_add3_u32 v250, v204, v205, v206
    v_add_u32 v242, v242, v203
    v_add_u32 v250, v250, v207
    v_lshl_add_u32 v242, v242, 1, v245
    v_lshl_add_u32 v250, v250, 1, v246
    v_cmp_gt_u32 vcc, v250, v242
    s_nop 1
    v_lshrrev_b64 v[240:241], v247, vcc
    v_and_b32 v240, 0xff, v240
    v_bcnt_u32_b32 v240, v240, 0
    v_cmp_eq_u32 vcc, s41, v240
    s_nop 0
    s_ff1_i32_b32 s54, vcc_lo
    s_mul_i32 s37, s54, 2784
    s_add_u32 s37, s37, 65536
    v_add_u32 v7, s37, v7
    v_add_u32 v8, s37, v8
    ds_read2_b64 v[232:235], v7 offset0:0 offset1:8
    ds_read_b32 v236, v8 offset:22272
    s_xor_b32 s58, s54, s3
    s_lshl_b32 s58, s58, 12
    v_xor_b32 v249, s58, v249
    s_lshl_b32 s39, s54, 3
    ds_read_b128 v[88:91], v249 offset:32768
    ds_read_b128 v[92:95], v249 offset:33792
    ds_read_b128 v[96:99], v249 offset:34816
    ds_read_b128 v[100:103], v249 offset:35840
    ds_read_u8 v15, v8 offset:3
    v_readlane_b32 s55, v200, s39
    s_xor_b32 s26, s26, s58
    s_xor_b32 s27, s27, s58
    s_lshl_b32 s38, s34, 3
    s_add_u32 s38, s38, s54
    s_mul_i32 s38, s38, 3125
    s_add_u32 s22, s38, 3252
    s_add_u32 s38, s38, 127
    s_and_b32 s38, s38, -128
    s_and_b32 s22, s22, -128
    s_add_u32 s59, s37, 128
    s_cmp_lt_u32 s55, s59
    s_cselect_b32 s29, 1, 0
    s_waitcnt lgkmcnt(5)
    v_and_or_b32 v232, v232, s25, v5
    v_and_or_b32 v233, v233, s25, v6
    v_and_or_b32 v234, v234, s25, v5
    v_and_or_b32 v235, v235, s25, v6
    v_and_or_b32 v236, v236, s35, v9
    s_waitcnt lgkmcnt(0)
    s_mov_b32 m0, s26
    s_nop 0
    buffer_load_dwordx4 v232, s[8:11], 0 offen lds
    s_add_u32 m0, m0, 1024
    s_nop 0
    buffer_load_dwordx4 v233, s[8:11], 0 offen lds
    s_add_u32 m0, m0, 1024
    s_nop 0
    buffer_load_dwordx4 v234, s[8:11], 0 offen lds
    s_add_u32 m0, m0, 1024
    s_nop 0
    buffer_load_dwordx4 v235, s[8:11], 0 offen lds
    buffer_load_dwordx4 v[240:243], v236, s[4:7], 0 offen
    v_xor_b32 v1, s58, v1
    v_xor_b32 v2, s58, v2
    v_xor_b32 v3, s58, v3
    v_xor_b32 v4, s58, v4
    ds_read_b128 v[168:171], v1 offset:0
    ds_read_b128 v[172:175], v2 offset:0
    ds_read_b128 v[176:179], v3 offset:0
    ds_read_b128 v[180:183], v4 offset:0
    ds_read_b128 v[184:187], v248 offset:26624
    ds_read_b128 v[188:191], v248 offset:27648
    ds_read_b128 v[208:211], v248 offset:28672
    ds_read_b128 v[212:215], v248 offset:29696
    ds_read_b128 v[216:219], v248 offset:30720
    ds_read_b128 v[220:223], v248 offset:31744
    ds_read_b128 v[224:227], v248 offset:32768
    ds_read_b128 v[228:231], v248 offset:33792
    ds_read_b128 v[80:83], v248 offset:16384
    ds_read_b128 v[84:87], v248 offset:17408
    ds_read_b128 v[16:19], v248 offset:8192
    ds_read_b128 v[20:23], v248 offset:9216
    ds_read_b128 v[24:27], v248 offset:10240
    ds_read_b128 v[28:31], v248 offset:11264
    ds_read_b128 v[32:35], v248 offset:12288
    ds_read_b128 v[36:39], v248 offset:13312
    ds_read_b128 v[40:43], v248 offset:14336
    ds_read_b128 v[44:47], v248 offset:15360
    ds_read_b128 v[48:51], v248 offset:18432
    ds_read_b128 v[52:55], v248 offset:19456
    ds_read_b128 v[56:59], v248 offset:20480
    ds_read_b128 v[60:63], v248 offset:21504
    ds_read_b128 v[64:67], v248 offset:22528
    ds_read_b128 v[68:71], v248 offset:23552
    ds_read_b128 v[72:75], v248 offset:24576
    ds_read_b128 v[76:79], v248 offset:25600
    v_add_u32 v244, s37, v255
    v_add_u32 v245, 1392, v244
    v_add_u32 v246, 2088, v244
    v_add_u32 v244, 696, v244
    v_lshl_add_u32 v237, v15, 1, v10
    v_lshl_add_u32 v238, v15, 1, v11
    v_mov_b32 v205, 0xf87fff80
    v_mov_b32 v206, 0x1ffffe0
    v_cndmask_b32 v197, v192, v193, s[44:45]
    v_cndmask_b32 v197, v197, v194, s[46:47]
    v_cndmask_b32 v197, v197, v195, s[48:49]
    s_waitcnt vmcnt(7) lgkmcnt(14)
    s_cmp_eq_u32 s30, 0
    s_cbranch_scc1 K2_TV
    s_mov_b64 exec, s[100:101]
    v_bitop3_b32 v138, v153, v155, s94 bitop3:0x7e
    v_bfe_u32 v136, v152, 1, 6
    v_cmp_lt_u32 vcc, s57, v138
    v_bfe_u32 v137, v154, 1, 6
    v_lshl_add_u32 v136, v136, 2, v199
    v_lshl_add_u32 v137, v137, 2, v199
    s_cbranch_vccnz K2_TR
    ds_add_rtn_u32 v144, v136, v198
    ds_add_rtn_u32 v145, v137, v198
    v_lshl_add_u32 v153, v153, 5, v197
    v_lshl_add_u32 v155, v155, 5, v197
    v_cmp_lt_u32_sdwa vcc, s40, v152 src0_sel:DWORD src1_sel:BYTE_2
    s_mov_b64 exec, -1
    v_mfma_f32_32x32x16_bf16 v[104:119], v[168:171], v[184:187], 0
    v_mfma_f32_32x32x16_bf16 v[120:135], v[168:171], v[188:191], 0
    s_mov_b64 exec, s[100:101]
    s_waitcnt lgkmcnt(0)
    v_min_u32 v144, s56, v144
    ds_write2st64_b32 v144, v152, v153 offset0:0 offset1:87
    v_min_u32 v145, s56, v145
    ds_write2st64_b32 v145, v154, v155 offset0:0 offset1:87
    s_mov_b64 exec, -1
    s_cbranch_vccnz K2_TM
K2_B3:
    s_waitcnt lgkmcnt(0)
    ds_read_b128 v[152:155], v12
    ds_read_b128 v[156:159], v12
    ds_read_b128 v[160:163], v12
    ds_read_b128 v[164:167], v12
    s_barrier
    ds_read_b128 v[200:203], v253
    ds_read_b32 v204, v251
    ds_read_b32 v247, v199 offset:256
    ds_read2st64_b32 v[136:137], v244 offset0:0 offset1:87
    ds_read2st64_b32 v[138:139], v244 offset0:1 offset1:88
    ds_read2st64_b32 v[142:143], v245 offset0:0 offset1:87
    ds_read2st64_b32 v[144:145], v245 offset0:1 offset1:88
    ds_read2st64_b32 v[148:149], v246 offset0:0 offset1:87
    ds_read2st64_b32 v[150:151], v246 offset0:1 offset1:88
    v_mfma_f32_32x32x16_bf16 v[104:119], v[172:175], v[208:211], v[104:119]
    v_mfma_f32_32x32x16_bf16 v[120:135], v[172:175], v[212:215], v[120:135]
    v_mfma_f32_32x32x16_bf16 v[104:119], v[176:179], v[216:219], v[104:119]
    v_mfma_f32_32x32x16_bf16 v[120:135], v[176:179], v[220:223], v[120:135]
    v_mfma_f32_32x32x16_bf16 v[104:119], v[180:183], v[224:227], v[104:119]
    v_mfma_f32_32x32x16_bf16 v[120:135], v[180:183], v[228:231], v[120:135]
    ds_read_b128 v[216:219], v237
    ds_read_b128 v[224:227], v12
    ds_read_b128 v[228:231], v12
    v_mov_b32 v220, 0xdddd
    s_mov_b32 s32, 800000
    s_add_u32 s46, s37, 696
    s_add_u32 s47, s37, 1392
    s_add_u32 s48, s37, 2088
    s_waitcnt lgkmcnt(9)
    v_readlane_b32 s40, v200, s39
    v_readlane_b32 s41, v201, s39
    v_readlane_b32 s42, v202, s39
    v_readlane_b32 s43, v203, s39
    v_readfirstlane_b32 s49, v247
    v_add3_u32 v200, v200, v201, v202
    v_cmp_lt_u32 s[50:51], v252, v204
    v_add_u32 v200, v200, v203
    v_cmp_lt_u32 vcc, v254, v200
    s_sub_u32 s44, s41, s46
    s_add_u32 s44, s44, s40
    s_sub_u32 s45, s42, s47
    s_add_u32 s45, s45, s44
    s_sub_u32 s24, s43, s48
    s_add_u32 s24, s24, s45
    v_add_u32 v244, s40, v255
    v_add_u32 v245, s44, v255
    v_add_u32 v246, s45, v255
    s_cbranch_vccnz K2_FB
    s_bitcmp0_b32 s49, 30
    s_cbranch_scc1 K2_FB
    s_cmp_lg_u32 s51, 0
    s_cbranch_scc1 K2_C3
    s_waitcnt lgkmcnt(3)
    ds_write2st64_b32 v244, v136, v137 offset0:0 offset1:87
    ds_write2st64_b32 v244, v138, v139 offset0:1 offset1:88
    ds_write2st64_b32 v245, v142, v143 offset0:0 offset1:87
    ds_write2st64_b32 v245, v144, v145 offset0:1 offset1:88
    ds_write2st64_b32 v246, v148, v149 offset0:0 offset1:87
    ds_write2st64_b32 v246, v150, v151 offset0:1 offset1:88
K2_R1:
    v_add_u32 v244, s24, v255
    s_sub_u32 s24, s24, s37
    s_add_u32 s24, s24, 127
    s_bfe_u32 s46, s24, 0x20005
    s_mov_b32 s47, s36
    s_lshr_b32 s24, s24, 7
    ds_write2st64_b32 v244, v205, v206 offset0:0 offset1:87
    ds_write2st64_b32 v244, v205, v206 offset0:1 offset1:88
    s_cmp_lg_u32 s29, 0
    s_cbranch_scc1 K2_G0
K2_G0R:
    ds_read2_b64 v[248:251], v7 offset0:16 offset1:24
    ds_read_b32 v252, v8 offset:22400
    ds_read2_b64 v[232:235], v7 offset0:32 offset1:40
    ds_read_b32 v236, v8 offset:22528
    s_mov_b32 s44, 0xbf30f25a
    s_waitcnt lgkmcnt(2)
    v_and_or_b32 v248, v248, s25, v5
    v_and_or_b32 v249, v249, s25, v6
    v_and_or_b32 v250, v250, s25, v5
    v_and_or_b32 v251, v251, s25, v6
    v_and_or_b32 v252, v252, s35, v9
    s_mov_b32 m0, s27
    s_nop 0
    buffer_load_dwordx4 v248, s[8:11], 0 offen lds
    s_add_u32 m0, m0, 1024
    s_nop 0
    buffer_load_dwordx4 v249, s[8:11], 0 offen lds
    s_add_u32 m0, m0, 1024
    s_nop 0
    buffer_load_dwordx4 v250, s[8:11], 0 offen lds
    s_add_u32 m0, m0, 1024
    s_nop 0
    buffer_load_dwordx4 v251, s[8:11], 0 offen lds
    buffer_load_dwordx4 v[188:191], v252, s[4:7], 0 offen
    v_mul_f32 v104, s47, v104
    v_mul_f32 v120, s47, v120
    v_mul_f32 v105, s47, v105
    v_mul_f32 v121, s47, v121
    v_mul_f32 v106, s47, v106
    v_mul_f32 v122, s47, v122
    v_mul_f32 v107, s47, v107
    v_mul_f32 v123, s47, v123
    v_mul_f32 v108, s47, v108
    v_mul_f32 v124, s47, v124
    v_mul_f32 v109, s47, v109
    v_mul_f32 v125, s47, v125
    v_mul_f32 v110, s47, v110
    v_mul_f32 v126, s47, v126
    v_mul_f32 v111, s47, v111
    v_mul_f32 v127, s47, v127
    v_mul_f32 v112, s47, v112
    v_mul_f32 v128, s47, v128
    v_mul_f32 v113, s47, v113
    v_mul_f32 v129, s47, v129
    v_mul_f32 v114, s47, v114
    v_mul_f32 v130, s47, v130
    v_mul_f32 v115, s47, v115
    v_mul_f32 v131, s47, v131
    v_mul_f32 v116, s47, v116
    v_mul_f32 v132, s47, v132
    s_waitcnt vmcnt(5)
    ds_read_b128 v[192:195], v1 offset:32768
    ds_read_b128 v[196:199], v2 offset:32768
    ds_read_b128 v[200:203], v3 offset:32768
    ds_read_b128 v[204:207], v4 offset:32768
    s_waitcnt lgkmcnt(0)
    v_mfma_f32_32x32x16_bf16 v[136:151], v[240:243], v[80:83], -0.5
    v_smfmac_f32_32x32x32_bf16 v[136:151], v[216:219], v[88:95], v219 abid:1
    v_mfma_f32_32x32x16_bf16 v[136:151], v[192:195], v[16:19], v[136:151]
    v_mfma_f32_32x32x16_bf16 v[136:151], v[196:199], v[24:27], v[136:151]
    v_mfma_f32_32x32x16_bf16 v[136:151], v[200:203], v[32:35], v[136:151]
    v_mfma_f32_32x32x16_bf16 v[136:151], v[204:207], v[40:43], v[136:151]
    v_and_or_b32 v232, v232, s25, v5
    v_and_or_b32 v233, v233, s25, v6
    v_and_or_b32 v234, v234, s25, v5
    v_and_or_b32 v235, v235, s25, v6
    v_and_or_b32 v236, v236, s35, v9
    s_mov_b32 m0, s26
    s_nop 0
    buffer_load_dwordx4 v232, s[8:11], 0 offen lds
    s_add_u32 m0, m0, 1024
    s_nop 0
    buffer_load_dwordx4 v233, s[8:11], 0 offen lds
    s_add_u32 m0, m0, 1024
    s_nop 0
    buffer_load_dwordx4 v234, s[8:11], 0 offen lds
    s_add_u32 m0, m0, 1024
    s_nop 0
    buffer_load_dwordx4 v235, s[8:11], 0 offen lds
    buffer_load_dwordx4 v[184:187], v236, s[4:7], 0 offen
    v_and_b32 v248, 31, v239
    v_lshlrev_b32 v248, 2, v248
    v_lshl_add_u32 v248, v9, 5, v248
    s_cmp_eq_u32 s24, 0
    s_cbranch_scc1 K2_DRAIN
    s_cmp_eq_u32 s24, 1
    s_cbranch_scc1 K2_T0
    s_lshl_b32 s41, s3, 2
    s_lshr_b32 s41, 0x54325432, s41
    s_and_b32 s41, s41, 15
    s_sub_u32 s41, s24, s41
    s_add_u32 s42, s41, 1
    s_mov_b32 s43, s10
    s_mov_b32 s45, s6
    s_nop 0
    s_cmp_lt_u32 s3, 4
    s_cbranch_scc1 K2_LOOP
K2_LOOPB:
    s_setprio 2
    ds_read_u8 v15, v8 offset:131
    ds_read_b32 v236, v8 offset:22656
    v_exp_f32 v136, v136
    v_exp_f32 v137, v137
    v_mfma_f32_32x32x16_bf16 v[168:183], v[192:195], v[48:51], 0
    v_exp_f32 v138, v138
    v_exp_f32 v139, v139
    v_exp_f32 v140, v140
    v_mfma_f32_32x32x16_bf16 v[168:183], v[196:199], v[56:59], v[168:183]
    v_exp_f32 v141, v141
    v_exp_f32 v142, v142
    v_exp_f32 v143, v143
    v_mfma_f32_32x32x16_bf16 v[168:183], v[200:203], v[64:67], v[168:183]
    v_exp_f32 v144, v144
    v_exp_f32 v145, v145
    v_exp_f32 v146, v146
    v_mfma_f32_32x32x16_bf16 v[168:183], v[204:207], v[72:75], v[168:183]
    v_exp_f32 v147, v147
    v_exp_f32 v148, v148
    v_exp_f32 v149, v149
    v_smfmac_f32_32x32x32_bf16 v[120:135], v[224:227], v[152:159], v220
    v_exp_f32 v150, v150
    v_smfmac_f32_32x32x32_bf16 v[120:135], v[228:231], v[160:167], v220
    ds_write_b16 v238, v13
    ds_read_b128 v[224:227], v12
    ds_read_b128 v[228:231], v12 offset:512
    ds_write_b16 v238, v14
    v_exp_f32 v151, v151
    s_setprio 0
    v_sub_f32 v136, s44, v136
    v_sub_f32 v137, s44, v137
    v_sub_f32 v138, s44, v138
    v_sub_f32 v139, s44, v139
    v_sub_f32 v140, s44, v140
    v_sub_f32 v141, s44, v141
    v_sub_f32 v142, s44, v142
    v_sub_f32 v143, s44, v143
    v_sub_f32 v144, s44, v144
    v_sub_f32 v145, s44, v145
    v_sub_f32 v146, s44, v146
    v_sub_f32 v147, s44, v147
    v_sub_f32 v148, s44, v148
    v_sub_f32 v149, s44, v149
    v_sub_f32 v150, s44, v150
    v_sub_f32 v151, s44, v151
    s_setprio 2
    v_rcp_f32 v136, v136
    v_rcp_f32 v137, v137
    v_mfma_f32_32x32x16_bf16 v[152:167], v[240:243], v[84:87], -0.5
    s_waitcnt lgkmcnt(4)
    v_rcp_f32 v138, v138
    v_rcp_f32 v139, v139
    v_lshl_add_u32 v237, v15, 1, v10
    v_and_or_b32 v236, v236, s35, v9
    v_smfmac_f32_32x32x32_bf16 v[152:167], v[216:219], v[96:103], v219 abid:1
    ds_read_b128 v[216:219], v237
    v_rcp_f32 v140, v140
    v_rcp_f32 v141, v141
    v_rcp_f32 v142, v142
    v_mfma_f32_32x32x16_bf16 v[152:167], v[192:195], v[20:23], v[152:167]
    ds_read2_b64 v[232:235], v7 offset0:48 offset1:56
    v_rcp_f32 v143, v143
    v_rcp_f32 v144, v144
    v_rcp_f32 v145, v145
    v_mfma_f32_32x32x16_bf16 v[152:167], v[196:199], v[28:31], v[152:167]
    v_rcp_f32 v146, v146
    v_rcp_f32 v147, v147
    v_rcp_f32 v148, v148
    v_mfma_f32_32x32x16_bf16 v[152:167], v[200:203], v[36:39], v[152:167]
    v_rcp_f32 v149, v149
    v_rcp_f32 v150, v150
    v_rcp_f32 v151, v151
    v_mfma_f32_32x32x16_bf16 v[152:167], v[204:207], v[44:47], v[152:167]
    s_setprio 0
    v_mul_f32 v136, v136, v168
    v_mul_f32 v137, v137, v169
    v_mul_f32 v138, v138, v170
    v_mul_f32 v139, v139, v171
    v_mul_f32 v140, v140, v172
    v_mul_f32 v141, v141, v173
    v_mul_f32 v142, v142, v174
    v_mul_f32 v143, v143, v175
    v_mul_f32 v144, v144, v176
    v_mul_f32 v145, v145, v177
    v_mul_f32 v146, v146, v178
    v_mul_f32 v147, v147, v179
    v_mul_f32 v148, v148, v180
    v_mul_f32 v149, v149, v181
    v_mul_f32 v150, v150, v182
    v_mul_f32 v151, v151, v183
    s_setprio 2
    s_waitcnt lgkmcnt(0)
    v_exp_f32 v152, v152
    v_exp_f32 v153, v153
    v_mfma_f32_32x32x16_bf16 v[168:183], v[192:195], v[52:55], 0
    v_exp_f32 v154, v154
    v_exp_f32 v155, v155
    v_exp_f32 v156, v156
    v_mfma_f32_32x32x16_bf16 v[168:183], v[196:199], v[60:63], v[168:183]
    v_exp_f32 v157, v157
    v_exp_f32 v158, v158
    v_exp_f32 v159, v159
    v_mfma_f32_32x32x16_bf16 v[168:183], v[200:203], v[68:71], v[168:183]
    v_exp_f32 v160, v160
    v_exp_f32 v161, v161
    v_exp_f32 v162, v162
    v_mfma_f32_32x32x16_bf16 v[168:183], v[204:207], v[76:79], v[168:183]
    s_waitcnt vmcnt(5)
    ds_read_b128 v[192:195], v1 offset:0
    ds_read_b128 v[196:199], v2 offset:0
    ds_read_b128 v[200:203], v3 offset:0
    ds_read_b128 v[204:207], v4 offset:0
    v_exp_f32 v163, v163
    v_exp_f32 v164, v164
    v_exp_f32 v165, v165
    v_smfmac_f32_32x32x32_bf16 v[104:119], v[224:227], v[136:143], v220
    v_exp_f32 v166, v166
    v_smfmac_f32_32x32x32_bf16 v[104:119], v[228:231], v[144:151], v220
    v_exp_f32 v167, v167
    s_setprio 0
    v_sub_f32 v152, s44, v152
    v_sub_f32 v153, s44, v153
    v_sub_f32 v154, s44, v154
    v_sub_f32 v155, s44, v155
    v_sub_f32 v156, s44, v156
    v_sub_f32 v157, s44, v157
    v_sub_f32 v158, s44, v158
    v_sub_f32 v159, s44, v159
    v_sub_f32 v160, s44, v160
    v_sub_f32 v161, s44, v161
    v_sub_f32 v162, s44, v162
    v_sub_f32 v163, s44, v163
    v_sub_f32 v164, s44, v164
    v_sub_f32 v165, s44, v165
    v_sub_f32 v166, s44, v166
    v_sub_f32 v167, s44, v167
    v_mov_b32 v244, v188
    v_mov_b32 v245, v189
    v_mov_b32 v246, v190
    v_mov_b32 v247, v191
    s_setprio 2
    v_rcp_f32 v152, v152
    v_rcp_f32 v153, v153
    v_mfma_f32_32x32x16_bf16 v[136:151], v[244:247], v[80:83], -0.5
    v_rcp_f32 v154, v154
    v_rcp_f32 v155, v155
    v_and_or_b32 v232, v232, s25, v5
    v_and_or_b32 v233, v233, s25, v6
    v_smfmac_f32_32x32x32_bf16 v[136:151], v[216:219], v[88:95], v219 abid:1
    v_rcp_f32 v156, v156
    v_rcp_f32 v157, v157
    v_and_or_b32 v234, v234, s25, v5
    v_and_or_b32 v235, v235, s25, v6
    v_lshl_add_u32 v238, v15, 1, v11
    s_waitcnt lgkmcnt(0)
    s_mov_b32 m0, s27
    v_mfma_f32_32x32x16_bf16 v[136:151], v[192:195], v[16:19], v[136:151]
    buffer_load_dwordx4 v232, s[8:11], 0 offen lds
    s_add_u32 m0, m0, 1024
    v_rcp_f32 v158, v158
    buffer_load_dwordx4 v233, s[8:11], 0 offen lds
    s_add_u32 m0, m0, 1024
    v_rcp_f32 v159, v159
    v_rcp_f32 v160, v160
    v_mfma_f32_32x32x16_bf16 v[136:151], v[196:199], v[24:27], v[136:151]
    buffer_load_dwordx4 v234, s[8:11], 0 offen lds
    s_add_u32 m0, m0, 1024
    v_rcp_f32 v161, v161
    buffer_load_dwordx4 v235, s[8:11], 0 offen lds
    v_rcp_f32 v162, v162
    v_rcp_f32 v163, v163
    v_mfma_f32_32x32x16_bf16 v[136:151], v[200:203], v[32:35], v[136:151]
    buffer_load_dwordx4 v[188:191], v236, s[4:7], 0 offen
    v_rcp_f32 v164, v164
    v_rcp_f32 v165, v165
    v_rcp_f32 v166, v166
    v_mfma_f32_32x32x16_bf16 v[136:151], v[204:207], v[40:43], v[136:151]
    v_rcp_f32 v167, v167
    s_setprio 0
    v_mul_f32 v152, v152, v168
    v_mul_f32 v153, v153, v169
    v_mul_f32 v154, v154, v170
    v_mul_f32 v155, v155, v171
    v_mul_f32 v156, v156, v172
    v_mul_f32 v157, v157, v173
    v_mul_f32 v158, v158, v174
    v_mul_f32 v159, v159, v175
    v_mul_f32 v160, v160, v176
    v_mul_f32 v161, v161, v177
    v_mul_f32 v162, v162, v178
    v_mul_f32 v163, v163, v179
    v_mul_f32 v164, v164, v180
    v_mul_f32 v165, v165, v181
    v_mul_f32 v166, v166, v182
    v_mul_f32 v167, v167, v183
    s_sub_u32 s24, s24, 1
    s_cmp_eq_u32 s24, 1
    s_cbranch_scc1 K2_T1
    s_cmp_eq_u32 s24, s42
    s_cselect_b32 s10, 0, s43
    s_cselect_b32 s6, 0, s45
    s_cmp_eq_u32 s24, s41
    s_cbranch_scc1 K2_LOOPBS_T
K2_LOOPB_1:
    s_setprio 2
    ds_read_u8 v15, v8 offset:259
    ds_read_b32 v236, v8 offset:22784
    v_exp_f32 v136, v136
    v_exp_f32 v137, v137
    v_mfma_f32_32x32x16_bf16 v[168:183], v[192:195], v[48:51], 0
    v_exp_f32 v138, v138
    v_exp_f32 v139, v139
    v_exp_f32 v140, v140
    v_mfma_f32_32x32x16_bf16 v[168:183], v[196:199], v[56:59], v[168:183]
    v_exp_f32 v141, v141
    v_exp_f32 v142, v142
    v_exp_f32 v143, v143
    v_mfma_f32_32x32x16_bf16 v[168:183], v[200:203], v[64:67], v[168:183]
    v_exp_f32 v144, v144
    v_exp_f32 v145, v145
    v_exp_f32 v146, v146
    v_mfma_f32_32x32x16_bf16 v[168:183], v[204:207], v[72:75], v[168:183]
    v_exp_f32 v147, v147
    v_exp_f32 v148, v148
    v_exp_f32 v149, v149
    v_smfmac_f32_32x32x32_bf16 v[120:135], v[224:227], v[152:159], v220
    v_exp_f32 v150, v150
    v_smfmac_f32_32x32x32_bf16 v[120:135], v[228:231], v[160:167], v220
    ds_write_b16 v238, v13
    ds_read_b128 v[224:227], v12
    ds_read_b128 v[228:231], v12 offset:512
    ds_write_b16 v238, v14
    v_exp_f32 v151, v151
    s_setprio 0
    v_sub_f32 v136, s44, v136
    v_sub_f32 v137, s44, v137
    v_sub_f32 v138, s44, v138
    v_sub_f32 v139, s44, v139
    v_sub_f32 v140, s44, v140
    v_sub_f32 v141, s44, v141
    v_sub_f32 v142, s44, v142
    v_sub_f32 v143, s44, v143
    v_sub_f32 v144, s44, v144
    v_sub_f32 v145, s44, v145
    v_sub_f32 v146, s44, v146
    v_sub_f32 v147, s44, v147
    v_sub_f32 v148, s44, v148
    v_sub_f32 v149, s44, v149
    v_sub_f32 v150, s44, v150
    v_sub_f32 v151, s44, v151
    s_setprio 2
    v_rcp_f32 v136, v136
    v_rcp_f32 v137, v137
    v_mfma_f32_32x32x16_bf16 v[152:167], v[244:247], v[84:87], -0.5
    s_waitcnt lgkmcnt(4)
    v_rcp_f32 v138, v138
    v_rcp_f32 v139, v139
    v_lshl_add_u32 v237, v15, 1, v10
    v_and_or_b32 v236, v236, s35, v9
    v_smfmac_f32_32x32x32_bf16 v[152:167], v[216:219], v[96:103], v219 abid:1
    ds_read_b128 v[216:219], v237
    v_rcp_f32 v140, v140
    v_rcp_f32 v141, v141
    v_rcp_f32 v142, v142
    v_mfma_f32_32x32x16_bf16 v[152:167], v[192:195], v[20:23], v[152:167]
    ds_read2_b64 v[232:235], v7 offset0:64 offset1:72
    v_rcp_f32 v143, v143
    v_rcp_f32 v144, v144
    v_rcp_f32 v145, v145
    v_mfma_f32_32x32x16_bf16 v[152:167], v[196:199], v[28:31], v[152:167]
    v_rcp_f32 v146, v146
    v_rcp_f32 v147, v147
    v_rcp_f32 v148, v148
    v_mfma_f32_32x32x16_bf16 v[152:167], v[200:203], v[36:39], v[152:167]
    v_rcp_f32 v149, v149
    v_rcp_f32 v150, v150
    v_rcp_f32 v151, v151
    v_add_u32 v7, 0x100, v7
    v_add_u32 v8, 0x100, v8
    v_mfma_f32_32x32x16_bf16 v[152:167], v[204:207], v[44:47], v[152:167]
    s_setprio 0
    v_mul_f32 v136, v136, v168
    v_mul_f32 v137, v137, v169
    v_mul_f32 v138, v138, v170
    v_mul_f32 v139, v139, v171
    v_mul_f32 v140, v140, v172
    v_mul_f32 v141, v141, v173
    v_mul_f32 v142, v142, v174
    v_mul_f32 v143, v143, v175
    v_mul_f32 v144, v144, v176
    v_mul_f32 v145, v145, v177
    v_mul_f32 v146, v146, v178
    v_mul_f32 v147, v147, v179
    v_mul_f32 v148, v148, v180
    v_mul_f32 v149, v149, v181
    v_mul_f32 v150, v150, v182
    v_mul_f32 v151, v151, v183
    s_setprio 2
    s_waitcnt lgkmcnt(0)
    v_exp_f32 v152, v152
    v_exp_f32 v153, v153
    v_mfma_f32_32x32x16_bf16 v[168:183], v[192:195], v[52:55], 0
    v_exp_f32 v154, v154
    v_exp_f32 v155, v155
    v_exp_f32 v156, v156
    v_mfma_f32_32x32x16_bf16 v[168:183], v[196:199], v[60:63], v[168:183]
    v_exp_f32 v157, v157
    v_exp_f32 v158, v158
    v_exp_f32 v159, v159
    v_mfma_f32_32x32x16_bf16 v[168:183], v[200:203], v[68:71], v[168:183]
    v_exp_f32 v160, v160
    v_exp_f32 v161, v161
    v_exp_f32 v162, v162
    v_mfma_f32_32x32x16_bf16 v[168:183], v[204:207], v[76:79], v[168:183]
    s_waitcnt vmcnt(5)
    ds_read_b128 v[192:195], v1 offset:32768
    ds_read_b128 v[196:199], v2 offset:32768
    ds_read_b128 v[200:203], v3 offset:32768
    ds_read_b128 v[204:207], v4 offset:32768
    v_exp_f32 v163, v163
    v_exp_f32 v164, v164
    v_exp_f32 v165, v165
    v_smfmac_f32_32x32x32_bf16 v[104:119], v[224:227], v[136:143], v220
    v_exp_f32 v166, v166
    v_smfmac_f32_32x32x32_bf16 v[104:119], v[228:231], v[144:151], v220
    v_exp_f32 v167, v167
    s_setprio 0
    v_sub_f32 v152, s44, v152
    v_sub_f32 v153, s44, v153
    v_sub_f32 v154, s44, v154
    v_sub_f32 v155, s44, v155
    v_sub_f32 v156, s44, v156
    v_sub_f32 v157, s44, v157
    v_sub_f32 v158, s44, v158
    v_sub_f32 v159, s44, v159
    v_sub_f32 v160, s44, v160
    v_sub_f32 v161, s44, v161
    v_sub_f32 v162, s44, v162
    v_sub_f32 v163, s44, v163
    v_sub_f32 v164, s44, v164
    v_sub_f32 v165, s44, v165
    v_sub_f32 v166, s44, v166
    v_sub_f32 v167, s44, v167
    v_mov_b32 v240, v184
    v_mov_b32 v241, v185
    v_mov_b32 v242, v186
    v_mov_b32 v243, v187
    s_setprio 2
    v_rcp_f32 v152, v152
    v_rcp_f32 v153, v153
    v_mfma_f32_32x32x16_bf16 v[136:151], v[240:243], v[80:83], -0.5
    v_rcp_f32 v154, v154
    v_rcp_f32 v155, v155
    v_and_or_b32 v232, v232, s25, v5
    v_and_or_b32 v233, v233, s25, v6
    v_smfmac_f32_32x32x32_bf16 v[136:151], v[216:219], v[88:95], v219 abid:1
    v_rcp_f32 v156, v156
    v_rcp_f32 v157, v157
    v_and_or_b32 v234, v234, s25, v5
    v_and_or_b32 v235, v235, s25, v6
    v_lshl_add_u32 v238, v15, 1, v11
    s_waitcnt lgkmcnt(0)
    s_mov_b32 m0, s26
    v_mfma_f32_32x32x16_bf16 v[136:151], v[192:195], v[16:19], v[136:151]
    buffer_load_dwordx4 v232, s[8:11], 0 offen lds
    s_add_u32 m0, m0, 1024
    v_rcp_f32 v158, v158
    buffer_load_dwordx4 v233, s[8:11], 0 offen lds
    s_add_u32 m0, m0, 1024
    v_rcp_f32 v159, v159
    v_rcp_f32 v160, v160
    v_mfma_f32_32x32x16_bf16 v[136:151], v[196:199], v[24:27], v[136:151]
    buffer_load_dwordx4 v234, s[8:11], 0 offen lds
    s_add_u32 m0, m0, 1024
    v_rcp_f32 v161, v161
    buffer_load_dwordx4 v235, s[8:11], 0 offen lds
    v_rcp_f32 v162, v162
    v_rcp_f32 v163, v163
    v_mfma_f32_32x32x16_bf16 v[136:151], v[200:203], v[32:35], v[136:151]
    buffer_load_dwordx4 v[184:187], v236, s[4:7], 0 offen
    v_rcp_f32 v164, v164
    v_rcp_f32 v165, v165
    v_rcp_f32 v166, v166
    v_mfma_f32_32x32x16_bf16 v[136:151], v[204:207], v[40:43], v[136:151]
    v_rcp_f32 v167, v167
    s_setprio 0
    v_mul_f32 v152, v152, v168
    v_mul_f32 v153, v153, v169
    v_mul_f32 v154, v154, v170
    v_mul_f32 v155, v155, v171
    v_mul_f32 v156, v156, v172
    v_mul_f32 v157, v157, v173
    v_mul_f32 v158, v158, v174
    v_mul_f32 v159, v159, v175
    v_mul_f32 v160, v160, v176
    v_mul_f32 v161, v161, v177
    v_mul_f32 v162, v162, v178
    v_mul_f32 v163, v163, v179
    v_mul_f32 v164, v164, v180
    v_mul_f32 v165, v165, v181
    v_mul_f32 v166, v166, v182
    v_mul_f32 v167, v167, v183
    s_sub_u32 s24, s24, 1
    s_cmp_eq_u32 s24, 1
    s_cbranch_scc1 K2_T0
    s_cmp_eq_u32 s24, s42
    s_cselect_b32 s10, 0, s43
    s_cselect_b32 s6, 0, s45
    s_cmp_eq_u32 s24, s41
    s_cbranch_scc0 K2_LOOPB
    s_waitcnt vmcnt(5)
    v_mov_b32 v244, v188
    v_mov_b32 v245, v189
    v_mov_b32 v246, v190
    v_mov_b32 v247, v191
K2_LOOPBS:
    s_setprio 2
    ds_read_u8 v15, v8 offset:131
    ds_read_b32 v236, v8 offset:22528
    v_exp_f32 v136, v136
    v_exp_f32 v137, v137
    v_mfma_f32_32x32x16_bf16 v[168:183], v[192:195], v[48:51], 0
    v_exp_f32 v138, v138
    v_exp_f32 v139, v139
    v_exp_f32 v140, v140
    v_mfma_f32_32x32x16_bf16 v[168:183], v[196:199], v[56:59], v[168:183]
    v_exp_f32 v141, v141
    v_exp_f32 v142, v142
    v_exp_f32 v143, v143
    v_mfma_f32_32x32x16_bf16 v[168:183], v[200:203], v[64:67], v[168:183]
    v_exp_f32 v144, v144
    v_exp_f32 v145, v145
    v_exp_f32 v146, v146
    v_mfma_f32_32x32x16_bf16 v[168:183], v[204:207], v[72:75], v[168:183]
    v_exp_f32 v147, v147
    v_exp_f32 v148, v148
    v_exp_f32 v149, v149
    v_smfmac_f32_32x32x32_bf16 v[120:135], v[224:227], v[152:159], v220
    v_exp_f32 v150, v150
    v_smfmac_f32_32x32x32_bf16 v[120:135], v[228:231], v[160:167], v220
    ds_write_b16 v238, v13
    ds_read_b128 v[224:227], v12
    ds_read_b128 v[228:231], v12 offset:512
    ds_write_b16 v238, v14
    v_exp_f32 v151, v151
    s_setprio 0
    v_sub_f32 v136, s44, v136
    v_sub_f32 v137, s44, v137
    v_sub_f32 v138, s44, v138
    v_sub_f32 v139, s44, v139
    v_sub_f32 v140, s44, v140
    v_sub_f32 v141, s44, v141
    v_sub_f32 v142, s44, v142
    v_sub_f32 v143, s44, v143
    v_sub_f32 v144, s44, v144
    v_sub_f32 v145, s44, v145
    v_sub_f32 v146, s44, v146
    v_sub_f32 v147, s44, v147
    v_sub_f32 v148, s44, v148
    v_sub_f32 v149, s44, v149
    v_sub_f32 v150, s44, v150
    v_sub_f32 v151, s44, v151
    s_setprio 2
    v_rcp_f32 v136, v136
    v_rcp_f32 v137, v137
    v_mfma_f32_32x32x16_bf16 v[152:167], v[240:243], v[84:87], -0.5
    s_waitcnt lgkmcnt(4)
    v_rcp_f32 v138, v138
    v_rcp_f32 v139, v139
    v_lshl_add_u32 v237, v15, 1, v10
    v_and_or_b32 v236, v236, s35, v9
    v_smfmac_f32_32x32x32_bf16 v[152:167], v[216:219], v[96:103], v219 abid:1
    ds_read_b128 v[216:219], v237
    v_rcp_f32 v140, v140
    v_rcp_f32 v141, v141
    v_rcp_f32 v142, v142
    v_mfma_f32_32x32x16_bf16 v[152:167], v[192:195], v[20:23], v[152:167]
    ds_read2_b64 v[232:235], v7 offset0:32 offset1:40
    v_rcp_f32 v143, v143
    v_rcp_f32 v144, v144
    v_rcp_f32 v145, v145
    v_mfma_f32_32x32x16_bf16 v[152:167], v[196:199], v[28:31], v[152:167]
    v_rcp_f32 v146, v146
    v_rcp_f32 v147, v147
    v_rcp_f32 v148, v148
    v_mfma_f32_32x32x16_bf16 v[152:167], v[200:203], v[36:39], v[152:167]
    v_rcp_f32 v149, v149
    v_rcp_f32 v150, v150
    v_rcp_f32 v151, v151
    v_mfma_f32_32x32x16_bf16 v[152:167], v[204:207], v[44:47], v[152:167]
    s_setprio 0
    v_mul_f32 v136, v136, v168
    v_mul_f32 v137, v137, v169
    v_mul_f32 v138, v138, v170
    v_mul_f32 v139, v139, v171
    v_mul_f32 v140, v140, v172
    v_mul_f32 v141, v141, v173
    v_mul_f32 v142, v142, v174
    v_mul_f32 v143, v143, v175
    v_mul_f32 v144, v144, v176
    v_mul_f32 v145, v145, v177
    v_mul_f32 v146, v146, v178
    v_mul_f32 v147, v147, v179
    v_mul_f32 v148, v148, v180
    v_mul_f32 v149, v149, v181
    v_mul_f32 v150, v150, v182
    v_mul_f32 v151, v151, v183
    s_setprio 2
    s_waitcnt lgkmcnt(0)
    v_exp_f32 v152, v152
    v_exp_f32 v153, v153
    v_mfma_f32_32x32x16_bf16 v[168:183], v[192:195], v[52:55], 0
    v_exp_f32 v154, v154
    v_exp_f32 v155, v155
    v_exp_f32 v156, v156
    v_mfma_f32_32x32x16_bf16 v[168:183], v[196:199], v[60:63], v[168:183]
    v_exp_f32 v157, v157
    v_exp_f32 v158, v158
    v_exp_f32 v159, v159
    v_mfma_f32_32x32x16_bf16 v[168:183], v[200:203], v[68:71], v[168:183]
    v_exp_f32 v160, v160
    v_exp_f32 v161, v161
    v_exp_f32 v162, v162
    v_mfma_f32_32x32x16_bf16 v[168:183], v[204:207], v[76:79], v[168:183]
    s_waitcnt vmcnt(0)
    ds_read_b128 v[192:195], v1 offset:0
    ds_read_b128 v[196:199], v2 offset:0
    ds_read_b128 v[200:203], v3 offset:0
    ds_read_b128 v[204:207], v4 offset:0
    v_exp_f32 v163, v163
    v_exp_f32 v164, v164
    v_exp_f32 v165, v165
    v_smfmac_f32_32x32x32_bf16 v[104:119], v[224:227], v[136:143], v220
    v_exp_f32 v166, v166
    v_smfmac_f32_32x32x32_bf16 v[104:119], v[228:231], v[144:151], v220
    v_exp_f32 v167, v167
    s_setprio 0
    v_sub_f32 v152, s44, v152
    v_sub_f32 v153, s44, v153
    v_sub_f32 v154, s44, v154
    v_sub_f32 v155, s44, v155
    v_sub_f32 v156, s44, v156
    v_sub_f32 v157, s44, v157
    v_sub_f32 v158, s44, v158
    v_sub_f32 v159, s44, v159
    v_sub_f32 v160, s44, v160
    v_sub_f32 v161, s44, v161
    v_sub_f32 v162, s44, v162
    v_sub_f32 v163, s44, v163
    v_sub_f32 v164, s44, v164
    v_sub_f32 v165, s44, v165
    v_sub_f32 v166, s44, v166
    v_sub_f32 v167, s44, v167
    s_setprio 2
    v_rcp_f32 v152, v152
    v_rcp_f32 v153, v153
    v_mfma_f32_32x32x16_bf16 v[136:151], v[244:247], v[80:83], -0.5
    v_rcp_f32 v154, v154
    v_rcp_f32 v155, v155
    v_and_or_b32 v232, v232, s25, v5
    v_and_or_b32 v233, v233, s25, v6
    v_smfmac_f32_32x32x32_bf16 v[136:151], v[216:219], v[88:95], v219 abid:1
    v_rcp_f32 v156, v156
    v_rcp_f32 v157, v157
    v_and_or_b32 v234, v234, s25, v5
    v_and_or_b32 v235, v235, s25, v6
    v_lshl_add_u32 v238, v15, 1, v11
    s_waitcnt lgkmcnt(0)
    s_mov_b32 m0, s26
    v_mfma_f32_32x32x16_bf16 v[136:151], v[192:195], v[16:19], v[136:151]
    buffer_load_dwordx4 v232, s[8:11], 0 offen lds
    s_add_u32 m0, m0, 1024
    v_rcp_f32 v158, v158
    buffer_load_dwordx4 v233, s[8:11], 0 offen lds
    s_add_u32 m0, m0, 1024
    v_rcp_f32 v159, v159
    v_rcp_f32 v160, v160
    v_mfma_f32_32x32x16_bf16 v[136:151], v[196:199], v[24:27], v[136:151]
    buffer_load_dwordx4 v234, s[8:11], 0 offen lds
    s_add_u32 m0, m0, 1024
    v_rcp_f32 v161, v161
    buffer_load_dwordx4 v235, s[8:11], 0 offen lds
    v_rcp_f32 v162, v162
    v_rcp_f32 v163, v163
    v_mfma_f32_32x32x16_bf16 v[136:151], v[200:203], v[32:35], v[136:151]
    buffer_load_dwordx4 v[240:243], v236, s[4:7], 0 offen
    v_rcp_f32 v164, v164
    v_rcp_f32 v165, v165
    v_rcp_f32 v166, v166
    v_mfma_f32_32x32x16_bf16 v[136:151], v[204:207], v[40:43], v[136:151]
    v_rcp_f32 v167, v167
    s_setprio 0
    v_mul_f32 v152, v152, v168
    v_mul_f32 v153, v153, v169
    v_mul_f32 v154, v154, v170
    v_mul_f32 v155, v155, v171
    v_mul_f32 v156, v156, v172
    v_mul_f32 v157, v157, v173
    v_mul_f32 v158, v158, v174
    v_mul_f32 v159, v159, v175
    v_mul_f32 v160, v160, v176
    v_mul_f32 v161, v161, v177
    v_mul_f32 v162, v162, v178
    v_mul_f32 v163, v163, v179
    v_mul_f32 v164, v164, v180
    v_mul_f32 v165, v165, v181
    v_mul_f32 v166, v166, v182
    v_mul_f32 v167, v167, v183
    s_sub_u32 s24, s24, 1
    s_cmp_eq_u32 s24, 1
    s_cbranch_scc1 K2_T1
K2_LOOPBS_1:
    s_setprio 2
    ds_read_u8 v15, v8 offset:259
    ds_read_b32 v236, v8 offset:22656
    v_exp_f32 v136, v136
    v_exp_f32 v137, v137
    v_mfma_f32_32x32x16_bf16 v[168:183], v[192:195], v[48:51], 0
    v_exp_f32 v138, v138
    v_exp_f32 v139, v139
    v_exp_f32 v140, v140
    v_mfma_f32_32x32x16_bf16 v[168:183], v[196:199], v[56:59], v[168:183]
    v_exp_f32 v141, v141
    v_exp_f32 v142, v142
    v_exp_f32 v143, v143
    v_mfma_f32_32x32x16_bf16 v[168:183], v[200:203], v[64:67], v[168:183]
    v_exp_f32 v144, v144
    v_exp_f32 v145, v145
    v_exp_f32 v146, v146
    v_mfma_f32_32x32x16_bf16 v[168:183], v[204:207], v[72:75], v[168:183]
    v_exp_f32 v147, v147
    v_exp_f32 v148, v148
    v_exp_f32 v149, v149
    v_smfmac_f32_32x32x32_bf16 v[120:135], v[224:227], v[152:159], v220
    v_exp_f32 v150, v150
    v_smfmac_f32_32x32x32_bf16 v[120:135], v[228:231], v[160:167], v220
    ds_write_b16 v238, v13
    ds_read_b128 v[224:227], v12
    ds_read_b128 v[228:231], v12 offset:512
    ds_write_b16 v238, v14
    v_exp_f32 v151, v151
    s_setprio 0
    v_sub_f32 v136, s44, v136
    v_sub_f32 v137, s44, v137
    v_sub_f32 v138, s44, v138
    v_sub_f32 v139, s44, v139
    v_sub_f32 v140, s44, v140
    v_sub_f32 v141, s44, v141
    v_sub_f32 v142, s44, v142
    v_sub_f32 v143, s44, v143
    v_sub_f32 v144, s44, v144
    v_sub_f32 v145, s44, v145
    v_sub_f32 v146, s44, v146
    v_sub_f32 v147, s44, v147
    v_sub_f32 v148, s44, v148
    v_sub_f32 v149, s44, v149
    v_sub_f32 v150, s44, v150
    v_sub_f32 v151, s44, v151
    s_setprio 2
    v_rcp_f32 v136, v136
    v_rcp_f32 v137, v137
    v_mfma_f32_32x32x16_bf16 v[152:167], v[244:247], v[84:87], -0.5
    s_waitcnt lgkmcnt(4)
    v_rcp_f32 v138, v138
    v_rcp_f32 v139, v139
    v_lshl_add_u32 v237, v15, 1, v10
    v_and_or_b32 v236, v236, s35, v9
    v_smfmac_f32_32x32x32_bf16 v[152:167], v[216:219], v[96:103], v219 abid:1
    ds_read_b128 v[216:219], v237
    v_rcp_f32 v140, v140
    v_rcp_f32 v141, v141
    v_rcp_f32 v142, v142
    v_mfma_f32_32x32x16_bf16 v[152:167], v[192:195], v[20:23], v[152:167]
    ds_read2_b64 v[232:235], v7 offset0:48 offset1:56
    v_rcp_f32 v143, v143
    v_rcp_f32 v144, v144
    v_rcp_f32 v145, v145
    v_mfma_f32_32x32x16_bf16 v[152:167], v[196:199], v[28:31], v[152:167]
    v_rcp_f32 v146, v146
    v_rcp_f32 v147, v147
    v_rcp_f32 v148, v148
    v_mfma_f32_32x32x16_bf16 v[152:167], v[200:203], v[36:39], v[152:167]
    v_rcp_f32 v149, v149
    v_rcp_f32 v150, v150
    v_rcp_f32 v151, v151
    v_add_u32 v7, 0x100, v7
    v_add_u32 v8, 0x100, v8
    v_mfma_f32_32x32x16_bf16 v[152:167], v[204:207], v[44:47], v[152:167]
    s_setprio 0
    v_mul_f32 v136, v136, v168
    v_mul_f32 v137, v137, v169
    v_mul_f32 v138, v138, v170
    v_mul_f32 v139, v139, v171
    v_mul_f32 v140, v140, v172
    v_mul_f32 v141, v141, v173
    v_mul_f32 v142, v142, v174
    v_mul_f32 v143, v143, v175
    v_mul_f32 v144, v144, v176
    v_mul_f32 v145, v145, v177
    v_mul_f32 v146, v146, v178
    v_mul_f32 v147, v147, v179
    v_mul_f32 v148, v148, v180
    v_mul_f32 v149, v149, v181
    v_mul_f32 v150, v150, v182
    v_mul_f32 v151, v151, v183
    s_setprio 2
    s_waitcnt lgkmcnt(0)
    v_exp_f32 v152, v152
    v_exp_f32 v153, v153
    v_mfma_f32_32x32x16_bf16 v[168:183], v[192:195], v[52:55], 0
    v_exp_f32 v154, v154
    v_exp_f32 v155, v155
    v_exp_f32 v156, v156
    v_mfma_f32_32x32x16_bf16 v[168:183], v[196:199], v[60:63], v[168:183]
    v_exp_f32 v157, v157
    v_exp_f32 v158, v158
    v_exp_f32 v159, v159
    v_mfma_f32_32x32x16_bf16 v[168:183], v[200:203], v[68:71], v[168:183]
    v_exp_f32 v160, v160
    v_exp_f32 v161, v161
    v_exp_f32 v162, v162
    v_mfma_f32_32x32x16_bf16 v[168:183], v[204:207], v[76:79], v[168:183]
    s_waitcnt vmcnt(0)
    ds_read_b128 v[192:195], v1 offset:32768
    ds_read_b128 v[196:199], v2 offset:32768
    ds_read_b128 v[200:203], v3 offset:32768
    ds_read_b128 v[204:207], v4 offset:32768
    v_exp_f32 v163, v163
    v_exp_f32 v164, v164
    v_exp_f32 v165, v165
    v_smfmac_f32_32x32x32_bf16 v[104:119], v[224:227], v[136:143], v220
    v_exp_f32 v166, v166
    v_smfmac_f32_32x32x32_bf16 v[104:119], v[228:231], v[144:151], v220
    v_exp_f32 v167, v167
    s_setprio 0
    v_sub_f32 v152, s44, v152
    v_sub_f32 v153, s44, v153
    v_sub_f32 v154, s44, v154
    v_sub_f32 v155, s44, v155
    v_sub_f32 v156, s44, v156
    v_sub_f32 v157, s44, v157
    v_sub_f32 v158, s44, v158
    v_sub_f32 v159, s44, v159
    v_sub_f32 v160, s44, v160
    v_sub_f32 v161, s44, v161
    v_sub_f32 v162, s44, v162
    v_sub_f32 v163, s44, v163
    v_sub_f32 v164, s44, v164
    v_sub_f32 v165, s44, v165
    v_sub_f32 v166, s44, v166
    v_sub_f32 v167, s44, v167
    s_setprio 2
    v_rcp_f32 v152, v152
    v_rcp_f32 v153, v153
    v_mfma_f32_32x32x16_bf16 v[136:151], v[240:243], v[80:83], -0.5
    v_rcp_f32 v154, v154
    v_rcp_f32 v155, v155
    v_and_or_b32 v232, v232, s25, v5
    v_and_or_b32 v233, v233, s25, v6
    v_smfmac_f32_32x32x32_bf16 v[136:151], v[216:219], v[88:95], v219 abid:1
    v_rcp_f32 v156, v156
    v_rcp_f32 v157, v157
    v_and_or_b32 v234, v234, s25, v5
    v_and_or_b32 v235, v235, s25, v6
    v_lshl_add_u32 v238, v15, 1, v11
    s_waitcnt lgkmcnt(0)
    s_mov_b32 m0, s27
    v_mfma_f32_32x32x16_bf16 v[136:151], v[192:195], v[16:19], v[136:151]
    buffer_load_dwordx4 v232, s[8:11], 0 offen lds
    s_add_u32 m0, m0, 1024
    v_rcp_f32 v158, v158
    buffer_load_dwordx4 v233, s[8:11], 0 offen lds
    s_add_u32 m0, m0, 1024
    v_rcp_f32 v159, v159
    v_rcp_f32 v160, v160
    v_mfma_f32_32x32x16_bf16 v[136:151], v[196:199], v[24:27], v[136:151]
    buffer_load_dwordx4 v234, s[8:11], 0 offen lds
    s_add_u32 m0, m0, 1024
    v_rcp_f32 v161, v161
    buffer_load_dwordx4 v235, s[8:11], 0 offen lds
    v_rcp_f32 v162, v162
    v_rcp_f32 v163, v163
    v_mfma_f32_32x32x16_bf16 v[136:151], v[200:203], v[32:35], v[136:151]
    buffer_load_dwordx4 v[244:247], v236, s[4:7], 0 offen
    v_rcp_f32 v164, v164
    v_rcp_f32 v165, v165
    v_rcp_f32 v166, v166
    v_mfma_f32_32x32x16_bf16 v[136:151], v[204:207], v[40:43], v[136:151]
    v_rcp_f32 v167, v167
    s_setprio 0
    v_mul_f32 v152, v152, v168
    v_mul_f32 v153, v153, v169
    v_mul_f32 v154, v154, v170
    v_mul_f32 v155, v155, v171
    v_mul_f32 v156, v156, v172
    v_mul_f32 v157, v157, v173
    v_mul_f32 v158, v158, v174
    v_mul_f32 v159, v159, v175
    v_mul_f32 v160, v160, v176
    v_mul_f32 v161, v161, v177
    v_mul_f32 v162, v162, v178
    v_mul_f32 v163, v163, v179
    v_mul_f32 v164, v164, v180
    v_mul_f32 v165, v165, v181
    v_mul_f32 v166, v166, v182
    v_mul_f32 v167, v167, v183
    s_sub_u32 s24, s24, 1
    s_cmp_eq_u32 s24, 1
    s_cbranch_scc0 K2_LOOPBS
    s_branch K2_T0
K2_TQ1:
    v_mfma_f32_32x32x16_bf16 v[168:183], v[192:195], v[48:51], 0
    v_sub_f32 v136, s44, v136
    v_sub_f32 v137, s44, v137
    v_sub_f32 v138, s44, v138
    v_sub_f32 v139, s44, v139
    v_rcp_f32 v136, v136
    v_mfma_f32_32x32x16_bf16 v[168:183], v[196:199], v[56:59], v[168:183]
    v_rcp_f32 v137, v137
    v_rcp_f32 v138, v138
    v_rcp_f32 v139, v139
    v_mfma_f32_32x32x16_bf16 v[168:183], v[200:203], v[64:67], v[168:183]
    v_mfma_f32_32x32x16_bf16 v[168:183], v[204:207], v[72:75], v[168:183]
    v_smfmac_f32_32x32x32_bf16 v[152:167], v[216:219], v[96:103], v219 abid:1
    v_mfma_f32_32x32x16_bf16 v[152:167], v[192:195], v[20:23], v[152:167]
    s_nop 9
    v_mul_f32 v136, v136, v168
    v_mul_f32 v137, v137, v169
    v_mul_f32 v138, v138, v170
    v_mul_f32 v139, v139, v171
    v_mfma_f32_32x32x16_bf16 v[152:167], v[196:199], v[28:31], v[152:167]
    v_mfma_f32_32x32x16_bf16 v[152:167], v[200:203], v[36:39], v[152:167]
    v_mfma_f32_32x32x16_bf16 v[152:167], v[204:207], v[44:47], v[152:167]
    s_waitcnt lgkmcnt(0)
    v_mfma_f32_32x32x16_bf16 v[168:183], v[192:195], v[52:55], 0
    v_mfma_f32_32x32x16_bf16 v[168:183], v[196:199], v[60:63], v[168:183]
    s_nop 8
    v_exp_f32 v152, v152
    v_exp_f32 v153, v153
    v_exp_f32 v154, v154
    v_mfma_f32_32x32x16_bf16 v[168:183], v[200:203], v[68:71], v[168:183]
    v_exp_f32 v155, v155
    v_sub_f32 v152, s44, v152
    v_sub_f32 v153, s44, v153
    v_sub_f32 v154, s44, v154
    v_sub_f32 v155, s44, v155
    v_mfma_f32_32x32x16_bf16 v[168:183], v[204:207], v[76:79], v[168:183]
    v_rcp_f32 v152, v152
    v_rcp_f32 v153, v153
    v_rcp_f32 v154, v154
    v_smfmac_f32_32x32x32_bf16 v[104:119], v[224:227], v[136:143], v220
    v_rcp_f32 v155, v155
    s_nop 6
    v_mul_f32 v152, v152, v168
    v_mul_f32 v153, v153, v169
    v_mul_f32 v154, v154, v170
    v_mul_f32 v155, v155, v171
    s_setprio 0
    s_nop 0
    v_smfmac_f32_32x32x32_bf16 v[120:135], v[224:227], v[152:159], v220
    s_branch K2_DR2
K2_TQ2:
    v_mfma_f32_32x32x16_bf16 v[168:183], v[192:195], v[48:51], 0
    v_exp_f32 v140, v140
    v_exp_f32 v141, v141
    v_exp_f32 v142, v142
    v_mfma_f32_32x32x16_bf16 v[168:183], v[196:199], v[56:59], v[168:183]
    v_exp_f32 v143, v143
    v_sub_f32 v136, s44, v136
    v_sub_f32 v137, s44, v137
    v_sub_f32 v138, s44, v138
    v_sub_f32 v139, s44, v139
    v_mfma_f32_32x32x16_bf16 v[168:183], v[200:203], v[64:67], v[168:183]
    v_sub_f32 v140, s44, v140
    v_sub_f32 v141, s44, v141
    v_sub_f32 v142, s44, v142
    v_sub_f32 v143, s44, v143
    v_rcp_f32 v136, v136
    v_mfma_f32_32x32x16_bf16 v[168:183], v[204:207], v[72:75], v[168:183]
    v_rcp_f32 v137, v137
    v_rcp_f32 v138, v138
    v_rcp_f32 v139, v139
    v_smfmac_f32_32x32x32_bf16 v[152:167], v[216:219], v[96:103], v219 abid:1
    v_rcp_f32 v140, v140
    v_rcp_f32 v141, v141
    v_rcp_f32 v142, v142
    v_mfma_f32_32x32x16_bf16 v[152:167], v[192:195], v[20:23], v[152:167]
    v_rcp_f32 v143, v143
    s_nop 2
    v_mul_f32 v136, v136, v168
    v_mul_f32 v137, v137, v169
    v_mul_f32 v138, v138, v170
    v_mul_f32 v139, v139, v171
    v_mfma_f32_32x32x16_bf16 v[152:167], v[196:199], v[28:31], v[152:167]
    v_mul_f32 v140, v140, v172
    v_mul_f32 v141, v141, v173
    v_mul_f32 v142, v142, v174
    v_mul_f32 v143, v143, v175
    v_mfma_f32_32x32x16_bf16 v[152:167], v[200:203], v[36:39], v[152:167]
    v_mfma_f32_32x32x16_bf16 v[152:167], v[204:207], v[44:47], v[152:167]
    s_waitcnt lgkmcnt(0)
    v_mfma_f32_32x32x16_bf16 v[168:183], v[192:195], v[52:55], 0
    v_mfma_f32_32x32x16_bf16 v[168:183], v[196:199], v[60:63], v[168:183]
    s_nop 8
    v_exp_f32 v152, v152
    v_exp_f32 v153, v153
    v_exp_f32 v154, v154
    v_mfma_f32_32x32x16_bf16 v[168:183], v[200:203], v[68:71], v[168:183]
    v_exp_f32 v155, v155
    v_exp_f32 v156, v156
    v_exp_f32 v157, v157
    v_mfma_f32_32x32x16_bf16 v[168:183], v[204:207], v[76:79], v[168:183]
    v_exp_f32 v158, v158
    v_exp_f32 v159, v159
    v_sub_f32 v152, s44, v152
    v_sub_f32 v153, s44, v153
    v_smfmac_f32_32x32x32_bf16 v[104:119], v[224:227], v[136:143], v220
    v_sub_f32 v154, s44, v154
    v_sub_f32 v155, s44, v155
    v_sub_f32 v156, s44, v156
    v_sub_f32 v157, s44, v157
    v_sub_f32 v158, s44, v158
    v_sub_f32 v159, s44, v159
    v_rcp_f32 v152, v152
    v_rcp_f32 v153, v153
    v_rcp_f32 v154, v154
    v_rcp_f32 v155, v155
    v_rcp_f32 v156, v156
    v_rcp_f32 v157, v157
    v_rcp_f32 v158, v158
    v_rcp_f32 v159, v159
    v_mul_f32 v152, v152, v168
    v_mul_f32 v153, v153, v169
    v_mul_f32 v154, v154, v170
    v_mul_f32 v155, v155, v171
    v_mul_f32 v156, v156, v172
    v_mul_f32 v157, v157, v173
    v_mul_f32 v158, v158, v174
    v_mul_f32 v159, v159, v175
    s_setprio 0
    s_nop 0
    v_smfmac_f32_32x32x32_bf16 v[120:135], v[224:227], v[152:159], v220
    s_branch K2_DR2
K2_TQ3:
    v_mfma_f32_32x32x16_bf16 v[168:183], v[192:195], v[48:51], 0
    v_exp_f32 v140, v140
    v_exp_f32 v141, v141
    v_exp_f32 v142, v142
    v_mfma_f32_32x32x16_bf16 v[168:183], v[196:199], v[56:59], v[168:183]
    v_exp_f32 v143, v143
    v_exp_f32 v144, v144
    v_exp_f32 v145, v145
    v_mfma_f32_32x32x16_bf16 v[168:183], v[200:203], v[64:67], v[168:183]
    v_exp_f32 v146, v146
    v_exp_f32 v147, v147
    v_sub_f32 v136, s44, v136
    v_sub_f32 v137, s44, v137
    v_mfma_f32_32x32x16_bf16 v[168:183], v[204:207], v[72:75], v[168:183]
    v_sub_f32 v138, s44, v138
    v_sub_f32 v139, s44, v139
    v_sub_f32 v140, s44, v140
    v_sub_f32 v141, s44, v141
    v_sub_f32 v142, s44, v142
    v_sub_f32 v143, s44, v143
    v_smfmac_f32_32x32x32_bf16 v[152:167], v[216:219], v[96:103], v219 abid:1
    v_sub_f32 v144, s44, v144
    v_sub_f32 v145, s44, v145
    v_sub_f32 v146, s44, v146
    v_sub_f32 v147, s44, v147
    v_rcp_f32 v136, v136
    v_mfma_f32_32x32x16_bf16 v[152:167], v[192:195], v[20:23], v[152:167]
    v_rcp_f32 v137, v137
    v_rcp_f32 v138, v138
    v_rcp_f32 v139, v139
    v_mfma_f32_32x32x16_bf16 v[152:167], v[196:199], v[28:31], v[152:167]
    v_rcp_f32 v140, v140
    v_rcp_f32 v141, v141
    v_rcp_f32 v142, v142
    v_mfma_f32_32x32x16_bf16 v[152:167], v[200:203], v[36:39], v[152:167]
    v_rcp_f32 v143, v143
    v_rcp_f32 v144, v144
    v_rcp_f32 v145, v145
    v_mfma_f32_32x32x16_bf16 v[152:167], v[204:207], v[44:47], v[152:167]
    v_rcp_f32 v146, v146
    v_rcp_f32 v147, v147
    v_mul_f32 v136, v136, v168
    v_mul_f32 v137, v137, v169
    v_mul_f32 v138, v138, v170
    v_mul_f32 v139, v139, v171
    v_mul_f32 v140, v140, v172
    v_mul_f32 v141, v141, v173
    v_mul_f32 v142, v142, v174
    v_mul_f32 v143, v143, v175
    v_mul_f32 v144, v144, v176
    v_mul_f32 v145, v145, v177
    v_mul_f32 v146, v146, v178
    v_mul_f32 v147, v147, v179
    s_waitcnt lgkmcnt(0)
    v_mfma_f32_32x32x16_bf16 v[168:183], v[192:195], v[52:55], 0
    v_exp_f32 v152, v152
    v_exp_f32 v153, v153
    v_exp_f32 v154, v154
    v_mfma_f32_32x32x16_bf16 v[168:183], v[196:199], v[60:63], v[168:183]
    v_exp_f32 v155, v155
    v_exp_f32 v156, v156
    v_exp_f32 v157, v157
    v_mfma_f32_32x32x16_bf16 v[168:183], v[200:203], v[68:71], v[168:183]
    v_exp_f32 v158, v158
    v_exp_f32 v159, v159
    v_exp_f32 v160, v160
    v_mfma_f32_32x32x16_bf16 v[168:183], v[204:207], v[76:79], v[168:183]
    v_exp_f32 v161, v161
    v_exp_f32 v162, v162
    v_exp_f32 v163, v163
    v_smfmac_f32_32x32x32_bf16 v[104:119], v[224:227], v[136:143], v220
    v_sub_f32 v152, s44, v152
    v_sub_f32 v153, s44, v153
    v_sub_f32 v154, s44, v154
    v_sub_f32 v155, s44, v155
    v_sub_f32 v156, s44, v156
    v_sub_f32 v157, s44, v157
    v_smfmac_f32_32x32x32_bf16 v[104:119], v[228:231], v[144:151], v220
    v_sub_f32 v158, s44, v158
    v_sub_f32 v159, s44, v159
    v_sub_f32 v160, s44, v160
    v_sub_f32 v161, s44, v161
    v_sub_f32 v162, s44, v162
    v_sub_f32 v163, s44, v163
    v_rcp_f32 v152, v152
    v_rcp_f32 v153, v153
    v_rcp_f32 v154, v154
    v_rcp_f32 v155, v155
    v_rcp_f32 v156, v156
    v_rcp_f32 v157, v157
    v_rcp_f32 v158, v158
    v_rcp_f32 v159, v159
    v_rcp_f32 v160, v160
    v_rcp_f32 v161, v161
    v_rcp_f32 v162, v162
    v_rcp_f32 v163, v163
    v_mul_f32 v152, v152, v168
    v_mul_f32 v153, v153, v169
    v_mul_f32 v154, v154, v170
    v_mul_f32 v155, v155, v171
    v_mul_f32 v156, v156, v172
    v_mul_f32 v157, v157, v173
    v_mul_f32 v158, v158, v174
    v_mul_f32 v159, v159, v175
    v_mul_f32 v160, v160, v176
    v_mul_f32 v161, v161, v177
    v_mul_f32 v162, v162, v178
    v_mul_f32 v163, v163, v179
    s_setprio 0
    s_branch K2_DRAIN
K2_T1:
    s_setprio 1
    v_smfmac_f32_32x32x32_bf16 v[120:135], v[224:227], v[152:159], v220
    v_exp_f32 v136, v136
    v_exp_f32 v137, v137
    v_smfmac_f32_32x32x32_bf16 v[120:135], v[228:231], v[160:167], v220
    ds_write_b16 v238, v13
    ds_read_b128 v[224:227], v12
    ds_read_b128 v[228:231], v12 offset:512
    ds_write_b16 v238, v14
    v_exp_f32 v138, v138
    v_exp_f32 v139, v139
    v_mfma_f32_32x32x16_bf16 v[152:167], v[244:247], v[84:87], -0.5
    s_branch K2_TC
K2_LOOP:
    s_setprio 1
    ds_read_u8 v15, v8 offset:131
    ds_read_b32 v236, v8 offset:22656
    v_exp_f32 v136, v136
    v_exp_f32 v137, v137
    v_mfma_f32_32x32x16_bf16 v[168:183], v[192:195], v[48:51], 0
    v_exp_f32 v138, v138
    v_exp_f32 v139, v139
    v_exp_f32 v140, v140
    v_mfma_f32_32x32x16_bf16 v[168:183], v[196:199], v[56:59], v[168:183]
    v_exp_f32 v141, v141
    v_exp_f32 v142, v142
    v_exp_f32 v143, v143
    v_mfma_f32_32x32x16_bf16 v[168:183], v[200:203], v[64:67], v[168:183]
    v_exp_f32 v144, v144
    v_exp_f32 v145, v145
    v_exp_f32 v146, v146
    v_mfma_f32_32x32x16_bf16 v[168:183], v[204:207], v[72:75], v[168:183]
    v_exp_f32 v147, v147
    v_exp_f32 v148, v148
    v_exp_f32 v149, v149
    v_smfmac_f32_32x32x32_bf16 v[120:135], v[224:227], v[152:159], v220
    v_exp_f32 v150, v150
    v_smfmac_f32_32x32x32_bf16 v[120:135], v[228:231], v[160:167], v220
    ds_write_b16 v238, v13
    ds_read_b128 v[224:227], v12
    ds_read_b128 v[228:231], v12 offset:512
    ds_write_b16 v238, v14
    v_exp_f32 v151, v151
    s_setprio 0
    v_sub_f32 v136, s44, v136
    v_sub_f32 v137, s44, v137
    v_sub_f32 v138, s44, v138
    v_sub_f32 v139, s44, v139
    v_sub_f32 v140, s44, v140
    v_sub_f32 v141, s44, v141
    v_sub_f32 v142, s44, v142
    v_sub_f32 v143, s44, v143
    v_sub_f32 v144, s44, v144
    v_sub_f32 v145, s44, v145
    v_sub_f32 v146, s44, v146
    v_sub_f32 v147, s44, v147
    v_sub_f32 v148, s44, v148
    v_sub_f32 v149, s44, v149
    v_sub_f32 v150, s44, v150
    v_sub_f32 v151, s44, v151
    s_setprio 1
    v_rcp_f32 v136, v136
    v_rcp_f32 v137, v137
    v_mfma_f32_32x32x16_bf16 v[152:167], v[240:243], v[84:87], -0.5
    s_waitcnt lgkmcnt(4)
    v_rcp_f32 v138, v138
    v_rcp_f32 v139, v139
    v_lshl_add_u32 v237, v15, 1, v10
    v_and_or_b32 v236, v236, s35, v9
    v_smfmac_f32_32x32x32_bf16 v[152:167], v[216:219], v[96:103], v219 abid:1
    ds_read_b128 v[216:219], v237
    v_rcp_f32 v140, v140
    v_rcp_f32 v141, v141
    v_rcp_f32 v142, v142
    v_mfma_f32_32x32x16_bf16 v[152:167], v[192:195], v[20:23], v[152:167]
    ds_read2_b64 v[232:235], v7 offset0:48 offset1:56
    v_rcp_f32 v143, v143
    v_rcp_f32 v144, v144
    v_rcp_f32 v145, v145
    v_mfma_f32_32x32x16_bf16 v[152:167], v[196:199], v[28:31], v[152:167]
    v_rcp_f32 v146, v146
    v_rcp_f32 v147, v147
    v_rcp_f32 v148, v148
    v_mfma_f32_32x32x16_bf16 v[152:167], v[200:203], v[36:39], v[152:167]
    v_rcp_f32 v149, v149
    v_rcp_f32 v150, v150
    v_rcp_f32 v151, v151
    v_mfma_f32_32x32x16_bf16 v[152:167], v[204:207], v[44:47], v[152:167]
    s_setprio 0
    v_mul_f32 v136, v136, v168
    v_mul_f32 v137, v137, v169
    v_mul_f32 v138, v138, v170
    v_mul_f32 v139, v139, v171
    v_mul_f32 v140, v140, v172
    v_mul_f32 v141, v141, v173
    v_mul_f32 v142, v142, v174
    v_mul_f32 v143, v143, v175
    v_mul_f32 v144, v144, v176
    v_mul_f32 v145, v145, v177
    v_mul_f32 v146, v146, v178
    v_mul_f32 v147, v147, v179
    v_mul_f32 v148, v148, v180
    v_mul_f32 v149, v149, v181
    v_mul_f32 v150, v150, v182
    v_mul_f32 v151, v151, v183
    s_setprio 1
    s_waitcnt lgkmcnt(0)
    v_exp_f32 v152, v152
    v_exp_f32 v153, v153
    v_mfma_f32_32x32x16_bf16 v[168:183], v[192:195], v[52:55], 0
    v_exp_f32 v154, v154
    v_exp_f32 v155, v155
    v_exp_f32 v156, v156
    v_mfma_f32_32x32x16_bf16 v[168:183], v[196:199], v[60:63], v[168:183]
    v_exp_f32 v157, v157
    v_exp_f32 v158, v158
    v_exp_f32 v159, v159
    v_mfma_f32_32x32x16_bf16 v[168:183], v[200:203], v[68:71], v[168:183]
    v_exp_f32 v160, v160
    v_exp_f32 v161, v161
    v_exp_f32 v162, v162
    v_mfma_f32_32x32x16_bf16 v[168:183], v[204:207], v[76:79], v[168:183]
    s_waitcnt vmcnt(5)
    ds_read_b128 v[192:195], v1 offset:0
    ds_read_b128 v[196:199], v2 offset:0
    ds_read_b128 v[200:203], v3 offset:0
    ds_read_b128 v[204:207], v4 offset:0
    v_exp_f32 v163, v163
    v_exp_f32 v164, v164
    v_exp_f32 v165, v165
    v_smfmac_f32_32x32x32_bf16 v[104:119], v[224:227], v[136:143], v220
    v_exp_f32 v166, v166
    v_smfmac_f32_32x32x32_bf16 v[104:119], v[228:231], v[144:151], v220
    v_exp_f32 v167, v167
    s_setprio 0
    v_sub_f32 v152, s44, v152
    v_sub_f32 v153, s44, v153
    v_sub_f32 v154, s44, v154
    v_sub_f32 v155, s44, v155
    v_sub_f32 v156, s44, v156
    v_sub_f32 v157, s44, v157
    v_sub_f32 v158, s44, v158
    v_sub_f32 v159, s44, v159
    v_sub_f32 v160, s44, v160
    v_sub_f32 v161, s44, v161
    v_sub_f32 v162, s44, v162
    v_sub_f32 v163, s44, v163
    v_sub_f32 v164, s44, v164
    v_sub_f32 v165, s44, v165
    v_sub_f32 v166, s44, v166
    v_sub_f32 v167, s44, v167
    v_mov_b32 v244, v188
    v_mov_b32 v245, v189
    v_mov_b32 v246, v190
    v_mov_b32 v247, v191
    s_setprio 1
    v_rcp_f32 v152, v152
    v_rcp_f32 v153, v153
    v_mfma_f32_32x32x16_bf16 v[136:151], v[244:247], v[80:83], -0.5
    v_rcp_f32 v154, v154
    v_rcp_f32 v155, v155
    v_and_or_b32 v232, v232, s25, v5
    v_and_or_b32 v233, v233, s25, v6
    v_smfmac_f32_32x32x32_bf16 v[136:151], v[216:219], v[88:95], v219 abid:1
    v_rcp_f32 v156, v156
    v_rcp_f32 v157, v157
    v_and_or_b32 v234, v234, s25, v5
    v_and_or_b32 v235, v235, s25, v6
    v_lshl_add_u32 v238, v15, 1, v11
    s_waitcnt lgkmcnt(0)
    s_mov_b32 m0, s27
    v_mfma_f32_32x32x16_bf16 v[136:151], v[192:195], v[16:19], v[136:151]
    buffer_load_dwordx4 v232, s[8:11], 0 offen lds
    s_add_u32 m0, m0, 1024
    v_rcp_f32 v158, v158
    buffer_load_dwordx4 v233, s[8:11], 0 offen lds
    s_add_u32 m0, m0, 1024
    v_rcp_f32 v159, v159
    v_rcp_f32 v160, v160
    v_mfma_f32_32x32x16_bf16 v[136:151], v[196:199], v[24:27], v[136:151]
    buffer_load_dwordx4 v234, s[8:11], 0 offen lds
    s_add_u32 m0, m0, 1024
    v_rcp_f32 v161, v161
    buffer_load_dwordx4 v235, s[8:11], 0 offen lds
    v_rcp_f32 v162, v162
    v_rcp_f32 v163, v163
    v_mfma_f32_32x32x16_bf16 v[136:151], v[200:203], v[32:35], v[136:151]
    buffer_load_dwordx4 v[188:191], v236, s[4:7], 0 offen
    v_rcp_f32 v164, v164
    v_rcp_f32 v165, v165
    v_rcp_f32 v166, v166
    v_mfma_f32_32x32x16_bf16 v[136:151], v[204:207], v[40:43], v[136:151]
    v_rcp_f32 v167, v167
    s_setprio 0
    v_mul_f32 v152, v152, v168
    v_mul_f32 v153, v153, v169
    v_mul_f32 v154, v154, v170
    v_mul_f32 v155, v155, v171
    v_mul_f32 v156, v156, v172
    v_mul_f32 v157, v157, v173
    v_mul_f32 v158, v158, v174
    v_mul_f32 v159, v159, v175
    v_mul_f32 v160, v160, v176
    v_mul_f32 v161, v161, v177
    v_mul_f32 v162, v162, v178
    v_mul_f32 v163, v163, v179
    v_mul_f32 v164, v164, v180
    v_mul_f32 v165, v165, v181
    v_mul_f32 v166, v166, v182
    v_mul_f32 v167, v167, v183
    s_sub_u32 s24, s24, 1
    s_cmp_eq_u32 s24, 1
    s_cbranch_scc1 K2_T1
    s_cmp_eq_u32 s24, s42
    s_cselect_b32 s10, 0, s43
    s_cselect_b32 s6, 0, s45
    s_cmp_eq_u32 s24, s41
    s_cbranch_scc1 K2_LOOPS_T
K2_LOOP_1:
    s_setprio 1
    ds_read_u8 v15, v8 offset:259
    ds_read_b32 v236, v8 offset:22784
    v_exp_f32 v136, v136
    v_exp_f32 v137, v137
    v_mfma_f32_32x32x16_bf16 v[168:183], v[192:195], v[48:51], 0
    v_exp_f32 v138, v138
    v_exp_f32 v139, v139
    v_exp_f32 v140, v140
    v_mfma_f32_32x32x16_bf16 v[168:183], v[196:199], v[56:59], v[168:183]
    v_exp_f32 v141, v141
    v_exp_f32 v142, v142
    v_exp_f32 v143, v143
    v_mfma_f32_32x32x16_bf16 v[168:183], v[200:203], v[64:67], v[168:183]
    v_exp_f32 v144, v144
    v_exp_f32 v145, v145
    v_exp_f32 v146, v146
    v_mfma_f32_32x32x16_bf16 v[168:183], v[204:207], v[72:75], v[168:183]
    v_exp_f32 v147, v147
    v_exp_f32 v148, v148
    v_exp_f32 v149, v149
    v_smfmac_f32_32x32x32_bf16 v[120:135], v[224:227], v[152:159], v220
    v_exp_f32 v150, v150
    v_smfmac_f32_32x32x32_bf16 v[120:135], v[228:231], v[160:167], v220
    ds_write_b16 v238, v13
    ds_read_b128 v[224:227], v12
    ds_read_b128 v[228:231], v12 offset:512
    ds_write_b16 v238, v14
    v_exp_f32 v151, v151
    s_setprio 0
    v_sub_f32 v136, s44, v136
    v_sub_f32 v137, s44, v137
    v_sub_f32 v138, s44, v138
    v_sub_f32 v139, s44, v139
    v_sub_f32 v140, s44, v140
    v_sub_f32 v141, s44, v141
    v_sub_f32 v142, s44, v142
    v_sub_f32 v143, s44, v143
    v_sub_f32 v144, s44, v144
    v_sub_f32 v145, s44, v145
    v_sub_f32 v146, s44, v146
    v_sub_f32 v147, s44, v147
    v_sub_f32 v148, s44, v148
    v_sub_f32 v149, s44, v149
    v_sub_f32 v150, s44, v150
    v_sub_f32 v151, s44, v151
    s_setprio 1
    v_rcp_f32 v136, v136
    v_rcp_f32 v137, v137
    v_mfma_f32_32x32x16_bf16 v[152:167], v[244:247], v[84:87], -0.5
    s_waitcnt lgkmcnt(4)
    v_rcp_f32 v138, v138
    v_rcp_f32 v139, v139
    v_lshl_add_u32 v237, v15, 1, v10
    v_and_or_b32 v236, v236, s35, v9
    v_smfmac_f32_32x32x32_bf16 v[152:167], v[216:219], v[96:103], v219 abid:1
    ds_read_b128 v[216:219], v237
    v_rcp_f32 v140, v140
    v_rcp_f32 v141, v141
    v_rcp_f32 v142, v142
    v_mfma_f32_32x32x16_bf16 v[152:167], v[192:195], v[20:23], v[152:167]
    ds_read2_b64 v[232:235], v7 offset0:64 offset1:72
    v_rcp_f32 v143, v143
    v_rcp_f32 v144, v144
    v_rcp_f32 v145, v145
    v_mfma_f32_32x32x16_bf16 v[152:167], v[196:199], v[28:31], v[152:167]
    v_rcp_f32 v146, v146
    v_rcp_f32 v147, v147
    v_rcp_f32 v148, v148
    v_mfma_f32_32x32x16_bf16 v[152:167], v[200:203], v[36:39], v[152:167]
    v_rcp_f32 v149, v149
    v_rcp_f32 v150, v150
    v_rcp_f32 v151, v151
    v_add_u32 v7, 0x100, v7
    v_add_u32 v8, 0x100, v8
    v_mfma_f32_32x32x16_bf16 v[152:167], v[204:207], v[44:47], v[152:167]
    s_setprio 0
    v_mul_f32 v136, v136, v168
    v_mul_f32 v137, v137, v169
    v_mul_f32 v138, v138, v170
    v_mul_f32 v139, v139, v171
    v_mul_f32 v140, v140, v172
    v_mul_f32 v141, v141, v173
    v_mul_f32 v142, v142, v174
    v_mul_f32 v143, v143, v175
    v_mul_f32 v144, v144, v176
    v_mul_f32 v145, v145, v177
    v_mul_f32 v146, v146, v178
    v_mul_f32 v147, v147, v179
    v_mul_f32 v148, v148, v180
    v_mul_f32 v149, v149, v181
    v_mul_f32 v150, v150, v182
    v_mul_f32 v151, v151, v183
    s_setprio 1
    s_waitcnt lgkmcnt(0)
    v_exp_f32 v152, v152
    v_exp_f32 v153, v153
    v_mfma_f32_32x32x16_bf16 v[168:183], v[192:195], v[52:55], 0
    v_exp_f32 v154, v154
    v_exp_f32 v155, v155
    v_exp_f32 v156, v156
    v_mfma_f32_32x32x16_bf16 v[168:183], v[196:199], v[60:63], v[168:183]
    v_exp_f32 v157, v157
    v_exp_f32 v158, v158
    v_exp_f32 v159, v159
    v_mfma_f32_32x32x16_bf16 v[168:183], v[200:203], v[68:71], v[168:183]
    v_exp_f32 v160, v160
    v_exp_f32 v161, v161
    v_exp_f32 v162, v162
    v_mfma_f32_32x32x16_bf16 v[168:183], v[204:207], v[76:79], v[168:183]
    s_waitcnt vmcnt(5)
    ds_read_b128 v[192:195], v1 offset:32768
    ds_read_b128 v[196:199], v2 offset:32768
    ds_read_b128 v[200:203], v3 offset:32768
    ds_read_b128 v[204:207], v4 offset:32768
    v_exp_f32 v163, v163
    v_exp_f32 v164, v164
    v_exp_f32 v165, v165
    v_smfmac_f32_32x32x32_bf16 v[104:119], v[224:227], v[136:143], v220
    v_exp_f32 v166, v166
    v_smfmac_f32_32x32x32_bf16 v[104:119], v[228:231], v[144:151], v220
    v_exp_f32 v167, v167
    s_setprio 0
    v_sub_f32 v152, s44, v152
    v_sub_f32 v153, s44, v153
    v_sub_f32 v154, s44, v154
    v_sub_f32 v155, s44, v155
    v_sub_f32 v156, s44, v156
    v_sub_f32 v157, s44, v157
    v_sub_f32 v158, s44, v158
    v_sub_f32 v159, s44, v159
    v_sub_f32 v160, s44, v160
    v_sub_f32 v161, s44, v161
    v_sub_f32 v162, s44, v162
    v_sub_f32 v163, s44, v163
    v_sub_f32 v164, s44, v164
    v_sub_f32 v165, s44, v165
    v_sub_f32 v166, s44, v166
    v_sub_f32 v167, s44, v167
    v_mov_b32 v240, v184
    v_mov_b32 v241, v185
    v_mov_b32 v242, v186
    v_mov_b32 v243, v187
    s_setprio 1
    v_rcp_f32 v152, v152
    v_rcp_f32 v153, v153
    v_mfma_f32_32x32x16_bf16 v[136:151], v[240:243], v[80:83], -0.5
    v_rcp_f32 v154, v154
    v_rcp_f32 v155, v155
    v_and_or_b32 v232, v232, s25, v5
    v_and_or_b32 v233, v233, s25, v6
    v_smfmac_f32_32x32x32_bf16 v[136:151], v[216:219], v[88:95], v219 abid:1
    v_rcp_f32 v156, v156
    v_rcp_f32 v157, v157
    v_and_or_b32 v234, v234, s25, v5
    v_and_or_b32 v235, v235, s25, v6
    v_lshl_add_u32 v238, v15, 1, v11
    s_waitcnt lgkmcnt(0)
    s_mov_b32 m0, s26
    v_mfma_f32_32x32x16_bf16 v[136:151], v[192:195], v[16:19], v[136:151]
    buffer_load_dwordx4 v232, s[8:11], 0 offen lds
    s_add_u32 m0, m0, 1024
    v_rcp_f32 v158, v158
    buffer_load_dwordx4 v233, s[8:11], 0 offen lds
    s_add_u32 m0, m0, 1024
    v_rcp_f32 v159, v159
    v_rcp_f32 v160, v160
    v_mfma_f32_32x32x16_bf16 v[136:151], v[196:199], v[24:27], v[136:151]
    buffer_load_dwordx4 v234, s[8:11], 0 offen lds
    s_add_u32 m0, m0, 1024
    v_rcp_f32 v161, v161
    buffer_load_dwordx4 v235, s[8:11], 0 offen lds
    v_rcp_f32 v162, v162
    v_rcp_f32 v163, v163
    v_mfma_f32_32x32x16_bf16 v[136:151], v[200:203], v[32:35], v[136:151]
    buffer_load_dwordx4 v[184:187], v236, s[4:7], 0 offen
    v_rcp_f32 v164, v164
    v_rcp_f32 v165, v165
    v_rcp_f32 v166, v166
    v_mfma_f32_32x32x16_bf16 v[136:151], v[204:207], v[40:43], v[136:151]
    v_rcp_f32 v167, v167
    s_setprio 0
    v_mul_f32 v152, v152, v168
    v_mul_f32 v153, v153, v169
    v_mul_f32 v154, v154, v170
    v_mul_f32 v155, v155, v171
    v_mul_f32 v156, v156, v172
    v_mul_f32 v157, v157, v173
    v_mul_f32 v158, v158, v174
    v_mul_f32 v159, v159, v175
    v_mul_f32 v160, v160, v176
    v_mul_f32 v161, v161, v177
    v_mul_f32 v162, v162, v178
    v_mul_f32 v163, v163, v179
    v_mul_f32 v164, v164, v180
    v_mul_f32 v165, v165, v181
    v_mul_f32 v166, v166, v182
    v_mul_f32 v167, v167, v183
    s_sub_u32 s24, s24, 1
    s_cmp_eq_u32 s24, 1
    s_cbranch_scc1 K2_T0
    s_cmp_eq_u32 s24, s42
    s_cselect_b32 s10, 0, s43
    s_cselect_b32 s6, 0, s45
    s_cmp_eq_u32 s24, s41
    s_cbranch_scc0 K2_LOOP
    s_waitcnt vmcnt(5)
    v_mov_b32 v244, v188
    v_mov_b32 v245, v189
    v_mov_b32 v246, v190
    v_mov_b32 v247, v191
K2_LOOPS:
    s_setprio 1
    ds_read_u8 v15, v8 offset:131
    ds_read_b32 v236, v8 offset:22528
    v_exp_f32 v136, v136
    v_exp_f32 v137, v137
    v_mfma_f32_32x32x16_bf16 v[168:183], v[192:195], v[48:51], 0
    v_exp_f32 v138, v138
    v_exp_f32 v139, v139
    v_exp_f32 v140, v140
    v_mfma_f32_32x32x16_bf16 v[168:183], v[196:199], v[56:59], v[168:183]
    v_exp_f32 v141, v141
    v_exp_f32 v142, v142
    v_exp_f32 v143, v143
    v_mfma_f32_32x32x16_bf16 v[168:183], v[200:203], v[64:67], v[168:183]
    v_exp_f32 v144, v144
    v_exp_f32 v145, v145
    v_exp_f32 v146, v146
    v_mfma_f32_32x32x16_bf16 v[168:183], v[204:207], v[72:75], v[168:183]
    v_exp_f32 v147, v147
    v_exp_f32 v148, v148
    v_exp_f32 v149, v149
    v_smfmac_f32_32x32x32_bf16 v[120:135], v[224:227], v[152:159], v220
    v_exp_f32 v150, v150
    v_smfmac_f32_32x32x32_bf16 v[120:135], v[228:231], v[160:167], v220
    ds_write_b16 v238, v13
    ds_read_b128 v[224:227], v12
    ds_read_b128 v[228:231], v12 offset:512
    ds_write_b16 v238, v14
    v_exp_f32 v151, v151
    s_setprio 0
    v_sub_f32 v136, s44, v136
    v_sub_f32 v137, s44, v137
    v_sub_f32 v138, s44, v138
    v_sub_f32 v139, s44, v139
    v_sub_f32 v140, s44, v140
    v_sub_f32 v141, s44, v141
    v_sub_f32 v142, s44, v142
    v_sub_f32 v143, s44, v143
    v_sub_f32 v144, s44, v144
    v_sub_f32 v145, s44, v145
    v_sub_f32 v146, s44, v146
    v_sub_f32 v147, s44, v147
    v_sub_f32 v148, s44, v148
    v_sub_f32 v149, s44, v149
    v_sub_f32 v150, s44, v150
    v_sub_f32 v151, s44, v151
    s_setprio 1
    v_rcp_f32 v136, v136
    v_rcp_f32 v137, v137
    v_mfma_f32_32x32x16_bf16 v[152:167], v[240:243], v[84:87], -0.5
    s_waitcnt lgkmcnt(4)
    v_rcp_f32 v138, v138
    v_rcp_f32 v139, v139
    v_lshl_add_u32 v237, v15, 1, v10
    v_and_or_b32 v236, v236, s35, v9
    v_smfmac_f32_32x32x32_bf16 v[152:167], v[216:219], v[96:103], v219 abid:1
    ds_read_b128 v[216:219], v237
    v_rcp_f32 v140, v140
    v_rcp_f32 v141, v141
    v_rcp_f32 v142, v142
    v_mfma_f32_32x32x16_bf16 v[152:167], v[192:195], v[20:23], v[152:167]
    ds_read2_b64 v[232:235], v7 offset0:32 offset1:40
    v_rcp_f32 v143, v143
    v_rcp_f32 v144, v144
    v_rcp_f32 v145, v145
    v_mfma_f32_32x32x16_bf16 v[152:167], v[196:199], v[28:31], v[152:167]
    v_rcp_f32 v146, v146
    v_rcp_f32 v147, v147
    v_rcp_f32 v148, v148
    v_mfma_f32_32x32x16_bf16 v[152:167], v[200:203], v[36:39], v[152:167]
    v_rcp_f32 v149, v149
    v_rcp_f32 v150, v150
    v_rcp_f32 v151, v151
    v_mfma_f32_32x32x16_bf16 v[152:167], v[204:207], v[44:47], v[152:167]
    s_setprio 0
    v_mul_f32 v136, v136, v168
    v_mul_f32 v137, v137, v169
    v_mul_f32 v138, v138, v170
    v_mul_f32 v139, v139, v171
    v_mul_f32 v140, v140, v172
    v_mul_f32 v141, v141, v173
    v_mul_f32 v142, v142, v174
    v_mul_f32 v143, v143, v175
    v_mul_f32 v144, v144, v176
    v_mul_f32 v145, v145, v177
    v_mul_f32 v146, v146, v178
    v_mul_f32 v147, v147, v179
    v_mul_f32 v148, v148, v180
    v_mul_f32 v149, v149, v181
    v_mul_f32 v150, v150, v182
    v_mul_f32 v151, v151, v183
    s_setprio 1
    s_waitcnt lgkmcnt(0)
    v_exp_f32 v152, v152
    v_exp_f32 v153, v153
    v_mfma_f32_32x32x16_bf16 v[168:183], v[192:195], v[52:55], 0
    v_exp_f32 v154, v154
    v_exp_f32 v155, v155
    v_exp_f32 v156, v156
    v_mfma_f32_32x32x16_bf16 v[168:183], v[196:199], v[60:63], v[168:183]
    v_exp_f32 v157, v157
    v_exp_f32 v158, v158
    v_exp_f32 v159, v159
    v_mfma_f32_32x32x16_bf16 v[168:183], v[200:203], v[68:71], v[168:183]
    v_exp_f32 v160, v160
    v_exp_f32 v161, v161
    v_exp_f32 v162, v162
    v_mfma_f32_32x32x16_bf16 v[168:183], v[204:207], v[76:79], v[168:183]
    s_waitcnt vmcnt(0)
    ds_read_b128 v[192:195], v1 offset:0
    ds_read_b128 v[196:199], v2 offset:0
    ds_read_b128 v[200:203], v3 offset:0
    ds_read_b128 v[204:207], v4 offset:0
    v_exp_f32 v163, v163
    v_exp_f32 v164, v164
    v_exp_f32 v165, v165
    v_smfmac_f32_32x32x32_bf16 v[104:119], v[224:227], v[136:143], v220
    v_exp_f32 v166, v166
    v_smfmac_f32_32x32x32_bf16 v[104:119], v[228:231], v[144:151], v220
    v_exp_f32 v167, v167
    s_setprio 0
    v_sub_f32 v152, s44, v152
    v_sub_f32 v153, s44, v153
    v_sub_f32 v154, s44, v154
    v_sub_f32 v155, s44, v155
    v_sub_f32 v156, s44, v156
    v_sub_f32 v157, s44, v157
    v_sub_f32 v158, s44, v158
    v_sub_f32 v159, s44, v159
    v_sub_f32 v160, s44, v160
    v_sub_f32 v161, s44, v161
    v_sub_f32 v162, s44, v162
    v_sub_f32 v163, s44, v163
    v_sub_f32 v164, s44, v164
    v_sub_f32 v165, s44, v165
    v_sub_f32 v166, s44, v166
    v_sub_f32 v167, s44, v167
    s_setprio 1
    v_rcp_f32 v152, v152
    v_rcp_f32 v153, v153
    v_mfma_f32_32x32x16_bf16 v[136:151], v[244:247], v[80:83], -0.5
    v_rcp_f32 v154, v154
    v_rcp_f32 v155, v155
    v_and_or_b32 v232, v232, s25, v5
    v_and_or_b32 v233, v233, s25, v6
    v_smfmac_f32_32x32x32_bf16 v[136:151], v[216:219], v[88:95], v219 abid:1
    v_rcp_f32 v156, v156
    v_rcp_f32 v157, v157
    v_and_or_b32 v234, v234, s25, v5
    v_and_or_b32 v235, v235, s25, v6
    v_lshl_add_u32 v238, v15, 1, v11
    s_waitcnt lgkmcnt(0)
    s_mov_b32 m0, s26
    v_mfma_f32_32x32x16_bf16 v[136:151], v[192:195], v[16:19], v[136:151]
    buffer_load_dwordx4 v232, s[8:11], 0 offen lds
    s_add_u32 m0, m0, 1024
    v_rcp_f32 v158, v158
    buffer_load_dwordx4 v233, s[8:11], 0 offen lds
    s_add_u32 m0, m0, 1024
    v_rcp_f32 v159, v159
    v_rcp_f32 v160, v160
    v_mfma_f32_32x32x16_bf16 v[136:151], v[196:199], v[24:27], v[136:151]
    buffer_load_dwordx4 v234, s[8:11], 0 offen lds
    s_add_u32 m0, m0, 1024
    v_rcp_f32 v161, v161
    buffer_load_dwordx4 v235, s[8:11], 0 offen lds
    v_rcp_f32 v162, v162
    v_rcp_f32 v163, v163
    v_mfma_f32_32x32x16_bf16 v[136:151], v[200:203], v[32:35], v[136:151]
    buffer_load_dwordx4 v[240:243], v236, s[4:7], 0 offen
    v_rcp_f32 v164, v164
    v_rcp_f32 v165, v165
    v_rcp_f32 v166, v166
    v_mfma_f32_32x32x16_bf16 v[136:151], v[204:207], v[40:43], v[136:151]
    v_rcp_f32 v167, v167
    s_setprio 0
    v_mul_f32 v152, v152, v168
    v_mul_f32 v153, v153, v169
    v_mul_f32 v154, v154, v170
    v_mul_f32 v155, v155, v171
    v_mul_f32 v156, v156, v172
    v_mul_f32 v157, v157, v173
    v_mul_f32 v158, v158, v174
    v_mul_f32 v159, v159, v175
    v_mul_f32 v160, v160, v176
    v_mul_f32 v161, v161, v177
    v_mul_f32 v162, v162, v178
    v_mul_f32 v163, v163, v179
    v_mul_f32 v164, v164, v180
    v_mul_f32 v165, v165, v181
    v_mul_f32 v166, v166, v182
    v_mul_f32 v167, v167, v183
    s_sub_u32 s24, s24, 1
    s_cmp_eq_u32 s24, 1
    s_cbranch_scc1 K2_T1
K2_LOOPS_1:
    s_setprio 1
    ds_read_u8 v15, v8 offset:259
    ds_read_b32 v236, v8 offset:22656
    v_exp_f32 v136, v136
    v_exp_f32 v137, v137
    v_mfma_f32_32x32x16_bf16 v[168:183], v[192:195], v[48:51], 0
    v_exp_f32 v138, v138
    v_exp_f32 v139, v139
    v_exp_f32 v140, v140
    v_mfma_f32_32x32x16_bf16 v[168:183], v[196:199], v[56:59], v[168:183]
    v_exp_f32 v141, v141
    v_exp_f32 v142, v142
    v_exp_f32 v143, v143
    v_mfma_f32_32x32x16_bf16 v[168:183], v[200:203], v[64:67], v[168:183]
    v_exp_f32 v144, v144
    v_exp_f32 v145, v145
    v_exp_f32 v146, v146
    v_mfma_f32_32x32x16_bf16 v[168:183], v[204:207], v[72:75], v[168:183]
    v_exp_f32 v147, v147
    v_exp_f32 v148, v148
    v_exp_f32 v149, v149
    v_smfmac_f32_32x32x32_bf16 v[120:135], v[224:227], v[152:159], v220
    v_exp_f32 v150, v150
    v_smfmac_f32_32x32x32_bf16 v[120:135], v[228:231], v[160:167], v220
    ds_write_b16 v238, v13
    ds_read_b128 v[224:227], v12
    ds_read_b128 v[228:231], v12 offset:512
    ds_write_b16 v238, v14
    v_exp_f32 v151, v151
    s_setprio 0
    v_sub_f32 v136, s44, v136
    v_sub_f32 v137, s44, v137
    v_sub_f32 v138, s44, v138
    v_sub_f32 v139, s44, v139
    v_sub_f32 v140, s44, v140
    v_sub_f32 v141, s44, v141
    v_sub_f32 v142, s44, v142
    v_sub_f32 v143, s44, v143
    v_sub_f32 v144, s44, v144
    v_sub_f32 v145, s44, v145
    v_sub_f32 v146, s44, v146
    v_sub_f32 v147, s44, v147
    v_sub_f32 v148, s44, v148
    v_sub_f32 v149, s44, v149
    v_sub_f32 v150, s44, v150
    v_sub_f32 v151, s44, v151
    s_setprio 1
    v_rcp_f32 v136, v136
    v_rcp_f32 v137, v137
    v_mfma_f32_32x32x16_bf16 v[152:167], v[244:247], v[84:87], -0.5
    s_waitcnt lgkmcnt(4)
    v_rcp_f32 v138, v138
    v_rcp_f32 v139, v139
    v_lshl_add_u32 v237, v15, 1, v10
    v_and_or_b32 v236, v236, s35, v9
    v_smfmac_f32_32x32x32_bf16 v[152:167], v[216:219], v[96:103], v219 abid:1
    ds_read_b128 v[216:219], v237
    v_rcp_f32 v140, v140
    v_rcp_f32 v141, v141
    v_rcp_f32 v142, v142
    v_mfma_f32_32x32x16_bf16 v[152:167], v[192:195], v[20:23], v[152:167]
    ds_read2_b64 v[232:235], v7 offset0:48 offset1:56
    v_rcp_f32 v143, v143
    v_rcp_f32 v144, v144
    v_rcp_f32 v145, v145
    v_mfma_f32_32x32x16_bf16 v[152:167], v[196:199], v[28:31], v[152:167]
    v_rcp_f32 v146, v146
    v_rcp_f32 v147, v147
    v_rcp_f32 v148, v148
    v_mfma_f32_32x32x16_bf16 v[152:167], v[200:203], v[36:39], v[152:167]
    v_rcp_f32 v149, v149
    v_rcp_f32 v150, v150
    v_rcp_f32 v151, v151
    v_add_u32 v7, 0x100, v7
    v_add_u32 v8, 0x100, v8
    v_mfma_f32_32x32x16_bf16 v[152:167], v[204:207], v[44:47], v[152:167]
    s_setprio 0
    v_mul_f32 v136, v136, v168
    v_mul_f32 v137, v137, v169
    v_mul_f32 v138, v138, v170
    v_mul_f32 v139, v139, v171
    v_mul_f32 v140, v140, v172
    v_mul_f32 v141, v141, v173
    v_mul_f32 v142, v142, v174
    v_mul_f32 v143, v143, v175
    v_mul_f32 v144, v144, v176
    v_mul_f32 v145, v145, v177
    v_mul_f32 v146, v146, v178
    v_mul_f32 v147, v147, v179
    v_mul_f32 v148, v148, v180
    v_mul_f32 v149, v149, v181
    v_mul_f32 v150, v150, v182
    v_mul_f32 v151, v151, v183
    s_setprio 1
    s_waitcnt lgkmcnt(0)
    v_exp_f32 v152, v152
    v_exp_f32 v153, v153
    v_mfma_f32_32x32x16_bf16 v[168:183], v[192:195], v[52:55], 0
    v_exp_f32 v154, v154
    v_exp_f32 v155, v155
    v_exp_f32 v156, v156
    v_mfma_f32_32x32x16_bf16 v[168:183], v[196:199], v[60:63], v[168:183]
    v_exp_f32 v157, v157
    v_exp_f32 v158, v158
    v_exp_f32 v159, v159
    v_mfma_f32_32x32x16_bf16 v[168:183], v[200:203], v[68:71], v[168:183]
    v_exp_f32 v160, v160
    v_exp_f32 v161, v161
    v_exp_f32 v162, v162
    v_mfma_f32_32x32x16_bf16 v[168:183], v[204:207], v[76:79], v[168:183]
    s_waitcnt vmcnt(0)
    ds_read_b128 v[192:195], v1 offset:32768
    ds_read_b128 v[196:199], v2 offset:32768
    ds_read_b128 v[200:203], v3 offset:32768
    ds_read_b128 v[204:207], v4 offset:32768
    v_exp_f32 v163, v163
    v_exp_f32 v164, v164
    v_exp_f32 v165, v165
    v_smfmac_f32_32x32x32_bf16 v[104:119], v[224:227], v[136:143], v220
    v_exp_f32 v166, v166
    v_smfmac_f32_32x32x32_bf16 v[104:119], v[228:231], v[144:151], v220
    v_exp_f32 v167, v167
    s_setprio 0
    v_sub_f32 v152, s44, v152
    v_sub_f32 v153, s44, v153
    v_sub_f32 v154, s44, v154
    v_sub_f32 v155, s44, v155
    v_sub_f32 v156, s44, v156
    v_sub_f32 v157, s44, v157
    v_sub_f32 v158, s44, v158
    v_sub_f32 v159, s44, v159
    v_sub_f32 v160, s44, v160
    v_sub_f32 v161, s44, v161
    v_sub_f32 v162, s44, v162
    v_sub_f32 v163, s44, v163
    v_sub_f32 v164, s44, v164
    v_sub_f32 v165, s44, v165
    v_sub_f32 v166, s44, v166
    v_sub_f32 v167, s44, v167
    s_setprio 1
    v_rcp_f32 v152, v152
    v_rcp_f32 v153, v153
    v_mfma_f32_32x32x16_bf16 v[136:151], v[240:243], v[80:83], -0.5
    v_rcp_f32 v154, v154
    v_rcp_f32 v155, v155
    v_and_or_b32 v232, v232, s25, v5
    v_and_or_b32 v233, v233, s25, v6
    v_smfmac_f32_32x32x32_bf16 v[136:151], v[216:219], v[88:95], v219 abid:1
    v_rcp_f32 v156, v156
    v_rcp_f32 v157, v157
    v_and_or_b32 v234, v234, s25, v5
    v_and_or_b32 v235, v235, s25, v6
    v_lshl_add_u32 v238, v15, 1, v11
    s_waitcnt lgkmcnt(0)
    s_mov_b32 m0, s27
    v_mfma_f32_32x32x16_bf16 v[136:151], v[192:195], v[16:19], v[136:151]
    buffer_load_dwordx4 v232, s[8:11], 0 offen lds
    s_add_u32 m0, m0, 1024
    v_rcp_f32 v158, v158
    buffer_load_dwordx4 v233, s[8:11], 0 offen lds
    s_add_u32 m0, m0, 1024
    v_rcp_f32 v159, v159
    v_rcp_f32 v160, v160
    v_mfma_f32_32x32x16_bf16 v[136:151], v[196:199], v[24:27], v[136:151]
    buffer_load_dwordx4 v234, s[8:11], 0 offen lds
    s_add_u32 m0, m0, 1024
    v_rcp_f32 v161, v161
    buffer_load_dwordx4 v235, s[8:11], 0 offen lds
    v_rcp_f32 v162, v162
    v_rcp_f32 v163, v163
    v_mfma_f32_32x32x16_bf16 v[136:151], v[200:203], v[32:35], v[136:151]
    buffer_load_dwordx4 v[244:247], v236, s[4:7], 0 offen
    v_rcp_f32 v164, v164
    v_rcp_f32 v165, v165
    v_rcp_f32 v166, v166
    v_mfma_f32_32x32x16_bf16 v[136:151], v[204:207], v[40:43], v[136:151]
    v_rcp_f32 v167, v167
    s_setprio 0
    v_mul_f32 v152, v152, v168
    v_mul_f32 v153, v153, v169
    v_mul_f32 v154, v154, v170
    v_mul_f32 v155, v155, v171
    v_mul_f32 v156, v156, v172
    v_mul_f32 v157, v157, v173
    v_mul_f32 v158, v158, v174
    v_mul_f32 v159, v159, v175
    v_mul_f32 v160, v160, v176
    v_mul_f32 v161, v161, v177
    v_mul_f32 v162, v162, v178
    v_mul_f32 v163, v163, v179
    v_mul_f32 v164, v164, v180
    v_mul_f32 v165, v165, v181
    v_mul_f32 v166, v166, v182
    v_mul_f32 v167, v167, v183
    s_sub_u32 s24, s24, 1
    s_cmp_eq_u32 s24, 1
    s_cbranch_scc0 K2_LOOPS
K2_T0:
    s_setprio 1
    v_smfmac_f32_32x32x32_bf16 v[120:135], v[224:227], v[152:159], v220
    v_exp_f32 v136, v136
    v_exp_f32 v137, v137
    v_smfmac_f32_32x32x32_bf16 v[120:135], v[228:231], v[160:167], v220
    ds_write_b16 v238, v13
    ds_read_b128 v[224:227], v12
    ds_read_b128 v[228:231], v12 offset:512
    ds_write_b16 v238, v14
    v_exp_f32 v138, v138
    v_exp_f32 v139, v139
    v_mfma_f32_32x32x16_bf16 v[152:167], v[240:243], v[84:87], -0.5
K2_TC:
    s_cmp_lt_u32 s46, 1
    s_cbranch_scc1 K2_TQ1
    s_cmp_lt_u32 s46, 2
    s_cbranch_scc1 K2_TQ2
    s_cmp_lt_u32 s46, 3
    s_cbranch_scc1 K2_TQ3
    v_mfma_f32_32x32x16_bf16 v[168:183], v[192:195], v[48:51], 0
    v_exp_f32 v140, v140
    v_exp_f32 v141, v141
    v_exp_f32 v142, v142
    v_mfma_f32_32x32x16_bf16 v[168:183], v[196:199], v[56:59], v[168:183]
    v_exp_f32 v143, v143
    v_exp_f32 v144, v144
    v_exp_f32 v145, v145
    v_mfma_f32_32x32x16_bf16 v[168:183], v[200:203], v[64:67], v[168:183]
    v_exp_f32 v146, v146
    v_exp_f32 v147, v147
    v_exp_f32 v148, v148
    v_mfma_f32_32x32x16_bf16 v[168:183], v[204:207], v[72:75], v[168:183]
    v_exp_f32 v149, v149
    v_exp_f32 v150, v150
    v_exp_f32 v151, v151
    v_smfmac_f32_32x32x32_bf16 v[152:167], v[216:219], v[96:103], v219 abid:1
    v_sub_f32 v136, s44, v136
    v_sub_f32 v137, s44, v137
    v_sub_f32 v138, s44, v138
    v_sub_f32 v139, s44, v139
    v_sub_f32 v140, s44, v140
    v_sub_f32 v141, s44, v141
    v_mfma_f32_32x32x16_bf16 v[152:167], v[192:195], v[20:23], v[152:167]
    v_sub_f32 v142, s44, v142
    v_sub_f32 v143, s44, v143
    v_sub_f32 v144, s44, v144
    v_sub_f32 v145, s44, v145
    v_sub_f32 v146, s44, v146
    v_sub_f32 v147, s44, v147
    v_mfma_f32_32x32x16_bf16 v[152:167], v[196:199], v[28:31], v[152:167]
    v_sub_f32 v148, s44, v148
    v_sub_f32 v149, s44, v149
    v_sub_f32 v150, s44, v150
    v_sub_f32 v151, s44, v151
    v_rcp_f32 v136, v136
    v_mfma_f32_32x32x16_bf16 v[152:167], v[200:203], v[36:39], v[152:167]
    v_rcp_f32 v137, v137
    v_rcp_f32 v138, v138
    v_rcp_f32 v139, v139
    v_mfma_f32_32x32x16_bf16 v[152:167], v[204:207], v[44:47], v[152:167]
    v_rcp_f32 v140, v140
    v_rcp_f32 v141, v141
    v_rcp_f32 v142, v142
    v_rcp_f32 v143, v143
    v_rcp_f32 v144, v144
    v_rcp_f32 v145, v145
    v_rcp_f32 v146, v146
    v_rcp_f32 v147, v147
    v_rcp_f32 v148, v148
    v_rcp_f32 v149, v149
    v_rcp_f32 v150, v150
    v_rcp_f32 v151, v151
    v_mul_f32 v136, v136, v168
    v_mul_f32 v137, v137, v169
    v_mul_f32 v138, v138, v170
    v_mul_f32 v139, v139, v171
    v_mul_f32 v140, v140, v172
    v_mul_f32 v141, v141, v173
    v_mul_f32 v142, v142, v174
    v_mul_f32 v143, v143, v175
    v_mul_f32 v144, v144, v176
    v_mul_f32 v145, v145, v177
    v_mul_f32 v146, v146, v178
    v_mul_f32 v147, v147, v179
    v_mul_f32 v148, v148, v180
    v_mul_f32 v149, v149, v181
    v_mul_f32 v150, v150, v182
    v_mul_f32 v151, v151, v183
    s_waitcnt lgkmcnt(0)
    v_mfma_f32_32x32x16_bf16 v[168:183], v[192:195], v[52:55], 0
    v_exp_f32 v152, v152
    v_exp_f32 v153, v153
    v_exp_f32 v154, v154
    v_mfma_f32_32x32x16_bf16 v[168:183], v[196:199], v[60:63], v[168:183]
    v_exp_f32 v155, v155
    v_exp_f32 v156, v156
    v_exp_f32 v157, v157
    v_mfma_f32_32x32x16_bf16 v[168:183], v[200:203], v[68:71], v[168:183]
    v_exp_f32 v158, v158
    v_exp_f32 v159, v159
    v_exp_f32 v160, v160
    v_mfma_f32_32x32x16_bf16 v[168:183], v[204:207], v[76:79], v[168:183]
    v_exp_f32 v161, v161
    v_exp_f32 v162, v162
    v_exp_f32 v163, v163
    v_smfmac_f32_32x32x32_bf16 v[104:119], v[224:227], v[136:143], v220
    v_exp_f32 v164, v164
    v_exp_f32 v165, v165
    v_exp_f32 v166, v166
    v_smfmac_f32_32x32x32_bf16 v[104:119], v[228:231], v[144:151], v220
    v_exp_f32 v167, v167
    v_sub_f32 v152, s44, v152
    v_sub_f32 v153, s44, v153
    v_sub_f32 v154, s44, v154
    v_sub_f32 v155, s44, v155
    v_sub_f32 v156, s44, v156
    v_sub_f32 v157, s44, v157
    v_sub_f32 v158, s44, v158
    v_sub_f32 v159, s44, v159
    v_sub_f32 v160, s44, v160
    v_sub_f32 v161, s44, v161
    v_sub_f32 v162, s44, v162
    v_sub_f32 v163, s44, v163
    v_sub_f32 v164, s44, v164
    v_sub_f32 v165, s44, v165
    v_sub_f32 v166, s44, v166
    v_sub_f32 v167, s44, v167
    v_rcp_f32 v152, v152
    v_rcp_f32 v153, v153
    v_rcp_f32 v154, v154
    v_rcp_f32 v155, v155
    v_rcp_f32 v156, v156
    v_rcp_f32 v157, v157
    v_rcp_f32 v158, v158
    v_rcp_f32 v159, v159
    v_rcp_f32 v160, v160
    v_rcp_f32 v161, v161
    v_rcp_f32 v162, v162
    v_rcp_f32 v163, v163
    v_rcp_f32 v164, v164
    v_rcp_f32 v165, v165
    v_rcp_f32 v166, v166
    v_rcp_f32 v167, v167
    v_mul_f32 v152, v152, v168
    v_mul_f32 v153, v153, v169
    v_mul_f32 v154, v154, v170
    v_mul_f32 v155, v155, v171
    v_mul_f32 v156, v156, v172
    v_mul_f32 v157, v157, v173
    v_mul_f32 v158, v158, v174
    v_mul_f32 v159, v159, v175
    v_mul_f32 v160, v160, v176
    v_mul_f32 v161, v161, v177
    v_mul_f32 v162, v162, v178
    v_mul_f32 v163, v163, v179
    v_mul_f32 v164, v164, v180
    v_mul_f32 v165, v165, v181
    v_mul_f32 v166, v166, v182
    v_mul_f32 v167, v167, v183
    s_setprio 0
K2_DRAIN:
    s_nop 1
    v_smfmac_f32_32x32x32_bf16 v[120:135], v[224:227], v[152:159], v220
    v_smfmac_f32_32x32x32_bf16 v[120:135], v[228:231], v[160:167], v220
K2_DR2:
    s_cmp_lt_u32 s32, 800000
    s_cbranch_scc1 K2_NEXT
    v_exp_f32 v136, v104
    v_exp_f32 v137, v105
    v_exp_f32 v138, v106
    v_exp_f32 v139, v107
    v_exp_f32 v140, v108
    v_exp_f32 v141, v109
    v_exp_f32 v142, v110
    v_exp_f32 v143, v111
    v_exp_f32 v144, v112
    v_exp_f32 v145, v113
    v_exp_f32 v146, v114
    v_exp_f32 v147, v115
    v_exp_f32 v148, v116
    v_pk_fma_f32 v[136:137], v[136:137], s[36:37], s[36:37] op_sel_hi:[1,0,0]
    v_pk_fma_f32 v[138:139], v[138:139], s[36:37], s[36:37] op_sel_hi:[1,0,0]
    v_pk_fma_f32 v[140:141], v[140:141], s[36:37], s[36:37] op_sel_hi:[1,0,0]
    v_pk_fma_f32 v[142:143], v[142:143], s[36:37], s[36:37] op_sel_hi:[1,0,0]
    v_pk_fma_f32 v[144:145], v[144:145], s[36:37], s[36:37] op_sel_hi:[1,0,0]
    v_pk_fma_f32 v[146:147], v[146:147], s[36:37], s[36:37] op_sel_hi:[1,0,0]
    v_fma_f32 v148, v148, s36, s36
    v_rcp_f32 v136, v136
    v_rcp_f32 v137, v137
    v_rcp_f32 v138, v138
    v_rcp_f32 v139, v139
    v_rcp_f32 v140, v140
    v_rcp_f32 v141, v141
    v_rcp_f32 v142, v142
    v_rcp_f32 v143, v143
    v_rcp_f32 v144, v144
    v_rcp_f32 v145, v145
    v_rcp_f32 v146, v146
    v_rcp_f32 v147, v147
    v_rcp_f32 v148, v148
    v_pk_mul_f32 v[136:137], v[136:137], v[104:105]
    v_pk_mul_f32 v[138:139], v[138:139], v[106:107]
    v_pk_mul_f32 v[140:141], v[140:141], v[108:109]
    v_pk_mul_f32 v[142:143], v[142:143], v[110:111]
    v_pk_mul_f32 v[144:145], v[144:145], v[112:113]
    v_pk_mul_f32 v[146:147], v[146:147], v[114:115]
    v_mul_f32 v148, v148, v116
    v_exp_f32 v152, v120
    v_exp_f32 v153, v121
    v_exp_f32 v154, v122
    v_exp_f32 v155, v123
    v_pk_fma_f32 v[152:153], v[152:153], s[36:37], s[36:37] op_sel_hi:[1,0,0]
    v_pk_fma_f32 v[154:155], v[154:155], s[36:37], s[36:37] op_sel_hi:[1,0,0]
    v_rcp_f32 v152, v152
    v_rcp_f32 v153, v153
    v_rcp_f32 v154, v154
    v_rcp_f32 v155, v155
    v_pk_mul_f32 v[152:153], v[152:153], v[120:121]
    v_pk_mul_f32 v[154:155], v[154:155], v[122:123]
    v_cvt_pk_bf16_f32 v168, v136, v152
    buffer_store_dword v168, v248, s[20:23], s38 offen offset:0 sc1
    v_cvt_pk_bf16_f32 v169, v137, v153
    buffer_store_dword v169, v248, s[20:23], s38 offen offset:128 sc1
    v_cvt_pk_bf16_f32 v170, v138, v154
    buffer_store_dword v170, v248, s[20:23], s38 offen offset:256 sc1
    v_cvt_pk_bf16_f32 v171, v139, v155
    buffer_store_dword v171, v248, s[20:23], s38 offen offset:384 sc1
    v_exp_f32 v156, v124
    v_exp_f32 v157, v125
    v_exp_f32 v158, v126
    v_exp_f32 v159, v127
    v_pk_fma_f32 v[156:157], v[156:157], s[36:37], s[36:37] op_sel_hi:[1,0,0]
    v_pk_fma_f32 v[158:159], v[158:159], s[36:37], s[36:37] op_sel_hi:[1,0,0]
    v_rcp_f32 v156, v156
    v_rcp_f32 v157, v157
    v_rcp_f32 v158, v158
    v_rcp_f32 v159, v159
    v_pk_mul_f32 v[156:157], v[156:157], v[124:125]
    v_pk_mul_f32 v[158:159], v[158:159], v[126:127]
    v_cvt_pk_bf16_f32 v172, v140, v156
    buffer_store_dword v172, v248, s[20:23], s38 offen offset:1024 sc1
    v_cvt_pk_bf16_f32 v173, v141, v157
    buffer_store_dword v173, v248, s[20:23], s38 offen offset:1152 sc1
    v_cvt_pk_bf16_f32 v174, v142, v158
    buffer_store_dword v174, v248, s[20:23], s38 offen offset:1280 sc1
    v_cvt_pk_bf16_f32 v175, v143, v159
    buffer_store_dword v175, v248, s[20:23], s38 offen offset:1408 sc1
    v_exp_f32 v160, v128
    v_exp_f32 v161, v129
    v_exp_f32 v162, v130
    v_exp_f32 v163, v131
    v_exp_f32 v164, v132
    v_pk_fma_f32 v[160:161], v[160:161], s[36:37], s[36:37] op_sel_hi:[1,0,0]
    v_pk_fma_f32 v[162:163], v[162:163], s[36:37], s[36:37] op_sel_hi:[1,0,0]
    v_fma_f32 v164, v164, s36, s36
    v_rcp_f32 v160, v160
    v_rcp_f32 v161, v161
    v_rcp_f32 v162, v162
    v_rcp_f32 v163, v163
    v_rcp_f32 v164, v164
    v_pk_mul_f32 v[160:161], v[160:161], v[128:129]
    v_pk_mul_f32 v[162:163], v[162:163], v[130:131]
    v_mul_f32 v164, v164, v132
    v_cvt_pk_bf16_f32 v176, v144, v160
    buffer_store_dword v176, v248, s[20:23], s38 offen offset:2048 sc1
    v_cvt_pk_bf16_f32 v177, v145, v161
    buffer_store_dword v177, v248, s[20:23], s38 offen offset:2176 sc1
    v_cvt_pk_bf16_f32 v178, v146, v162
    buffer_store_dword v178, v248, s[20:23], s38 offen offset:2304 sc1
    v_cvt_pk_bf16_f32 v179, v147, v163
    buffer_store_dword v179, v248, s[20:23], s38 offen offset:2432 sc1
    v_cvt_pk_bf16_f32 v180, v148, v164
    buffer_store_dword v180, v248, s[20:23], s38 offen offset:3072 sc1
K2_END:
    s_endpgm
K2_WS:
    s_cmp_lg_u32 s3, 7
    s_cbranch_scc1 K2_W4
    v_add_u32 v251, 0x800, v251
    ds_read2_b32 v[32:33], v251 offset0:0 offset1:32
    ds_read2_b32 v[34:35], v251 offset0:64 offset1:96
    ds_read2_b32 v[36:37], v251 offset0:128 offset1:160
    ds_read2_b32 v[38:39], v251 offset0:192 offset1:224
K2_W4:
    v_lshlrev_b32 v40, 16, v16
    v_and_b32 v48, 0xffff0000, v16
    v_lshlrev_b32 v41, 16, v17
    v_and_b32 v49, 0xffff0000, v17
    v_lshlrev_b32 v42, 16, v18
    v_and_b32 v50, 0xffff0000, v18
    v_lshlrev_b32 v43, 16, v19
    v_and_b32 v51, 0xffff0000, v19
    v_lshlrev_b32 v44, 16, v20
    v_and_b32 v52, 0xffff0000, v20
    v_lshlrev_b32 v45, 16, v21
    v_and_b32 v53, 0xffff0000, v21
    v_lshlrev_b32 v46, 16, v22
    v_and_b32 v54, 0xffff0000, v22
    v_lshlrev_b32 v47, 16, v23
    v_and_b32 v55, 0xffff0000, v23
    v_pk_mul_f32 v[40:41], v[40:41], s[36:37]
    v_pk_mul_f32 v[42:43], v[42:43], s[36:37]
    v_pk_mul_f32 v[44:45], v[44:45], s[36:37]
    v_pk_mul_f32 v[46:47], v[46:47], s[36:37]
    v_pk_mul_f32 v[48:49], v[48:49], s[36:37]
    v_pk_mul_f32 v[50:51], v[50:51], s[36:37]
    v_pk_mul_f32 v[52:53], v[52:53], s[36:37]
    v_pk_mul_f32 v[54:55], v[54:55], s[36:37]
    v_cvt_pk_bf16_f32 v64, v40, v41
    v_cvt_pk_bf16_f32 v65, v42, v43
    v_cvt_pk_bf16_f32 v66, v44, v45
    v_cvt_pk_bf16_f32 v67, v46, v47
    v_cvt_pk_bf16_f32 v68, v48, v49
    v_cvt_pk_bf16_f32 v69, v50, v51
    v_cvt_pk_bf16_f32 v70, v52, v53
    v_cvt_pk_bf16_f32 v71, v54, v55
    s_cbranch_scc1 K2_WSR
    s_waitcnt lgkmcnt(0)
    v_perm_b32 v72, v33, v32, s48
    v_perm_b32 v76, v33, v32, s49
    v_perm_b32 v73, v35, v34, s48
    v_perm_b32 v77, v35, v34, s49
    v_perm_b32 v74, v37, v36, s48
    v_perm_b32 v78, v37, v36, s49
    v_perm_b32 v75, v39, v38, s48
    v_perm_b32 v79, v39, v38, s49
    ds_write_b128 v253, v[72:75] offset:2048
    ds_write_b128 v253, v[76:79] offset:3072
    s_branch K2_WSR
K2_LOOPBS_T:
    s_waitcnt vmcnt(5)
    v_mov_b32 v240, v184
    v_mov_b32 v241, v185
    v_mov_b32 v242, v186
    v_mov_b32 v243, v187
    s_branch K2_LOOPBS_1
K2_LOOPS_T:
    s_waitcnt vmcnt(5)
    v_mov_b32 v240, v184
    v_mov_b32 v241, v185
    v_mov_b32 v242, v186
    v_mov_b32 v243, v187
    s_branch K2_LOOPS_1
K2_EP:
    s_mov_b64 exec, 1
    v_mov_b32 v242, 0x9e377000
    buffer_atomic_add v242, v14, s[12:15], 0 offen sc1
    s_mov_b64 exec, -1
    s_branch K2_EPR
K2_G0:
    ds_read2_b64 v[232:235], v7 offset0:0 offset1:8
    ds_read_b32 v236, v8 offset:22272
    ds_read_u8 v15, v8 offset:3
    s_waitcnt lgkmcnt(0)
    v_and_or_b32 v232, v232, s25, v5
    v_and_or_b32 v233, v233, s25, v6
    v_and_or_b32 v234, v234, s25, v5
    v_and_or_b32 v235, v235, s25, v6
    v_and_or_b32 v236, v236, s35, v9
    s_mov_b32 m0, s26
    s_nop 0
    buffer_load_dwordx4 v232, s[8:11], 0 offen lds
    s_add_u32 m0, m0, 1024
    s_nop 0
    buffer_load_dwordx4 v233, s[8:11], 0 offen lds
    s_add_u32 m0, m0, 1024
    s_nop 0
    buffer_load_dwordx4 v234, s[8:11], 0 offen lds
    s_add_u32 m0, m0, 1024
    s_nop 0
    buffer_load_dwordx4 v235, s[8:11], 0 offen lds
    buffer_load_dwordx4 v[240:243], v236, s[4:7], 0 offen
    v_lshl_add_u32 v237, v15, 1, v10
    v_lshl_add_u32 v238, v15, 1, v11
    ds_read_b128 v[216:219], v237
    ds_read_b128 v[152:155], v12
    ds_read_b128 v[156:159], v12
    ds_read_b128 v[160:163], v12
    ds_read_b128 v[164:167], v12
    ds_read_b128 v[224:227], v12
    ds_read_b128 v[228:231], v12
    s_branch K2_G0R
K2_C3:
    v_add_u32 v252, 184, v252
    v_cmp_lt_u32 vcc, v252, v204
    v_add_u32 v200, s46, v255
    v_add_u32 v201, s47, v255
    v_add_u32 v202, s48, v255
    s_cmp_lg_u32 vcc_hi, 0
    s_cbranch_scc1 K2_FB
    ds_read2st64_b32 v[140:141], v200 offset0:2 offset1:89
    ds_read2st64_b32 v[146:147], v201 offset0:2 offset1:89
    ds_read2st64_b32 v[152:153], v202 offset0:2 offset1:89
    s_waitcnt lgkmcnt(0)
    ds_write2st64_b32 v244, v136, v137 offset0:0 offset1:87
    ds_write2st64_b32 v244, v138, v139 offset0:1 offset1:88
    ds_write2st64_b32 v244, v140, v141 offset0:2 offset1:89
    ds_write2st64_b32 v245, v142, v143 offset0:0 offset1:87
    ds_write2st64_b32 v245, v144, v145 offset0:1 offset1:88
    ds_write2st64_b32 v245, v146, v147 offset0:2 offset1:89
    ds_write2st64_b32 v246, v148, v149 offset0:0 offset1:87
    ds_write2st64_b32 v246, v150, v151 offset0:1 offset1:88
    ds_write2st64_b32 v246, v152, v153 offset0:2 offset1:89
    v_mov_b32 v152, 0
    v_mov_b32 v153, 0
    s_branch K2_R1
K2_P2:
    s_cmp_lg_u32 s28, 0
    s_mov_b32 s28, 0
    s_cbranch_scc1 K2_P2R
    s_mov_b32 s28, 1
    s_barrier
    ds_write_b128 v236, v[232:235] offset:0
    ds_write_b128 v236, v[232:235] offset:8192
    ds_write_b128 v236, v[232:235] offset:16384
    ds_write_b128 v236, v[232:235] offset:24576
    ds_write_b128 v236, v[232:235] offset:32768
    ds_write_b128 v236, v[232:235] offset:40960
    ds_write_b128 v236, v[232:235] offset:49152
    ds_write_b128 v236, v[232:235] offset:57344
    ds_write_b128 v237, v[232:235]
    v_add_u32 v138, 32, v138
    s_waitcnt vmcnt(0) lgkmcnt(0)
    s_barrier
    v_subrev_u32 v154, 32, v154
    v_min_u32 v124, 32, v154
    v_lshl_add_u32 v124, v124, 3, v161
    ds_write_b64 v124, v[140:141] offset:33792
    v_subrev_u32 v155, 32, v155
    v_min_u32 v125, 32, v155
    v_lshl_add_u32 v125, v125, 3, v162
    ds_write_b64 v125, v[142:143] offset:33792
    v_subrev_u32 v156, 32, v156
    v_min_u32 v126, 32, v156
    v_lshl_add_u32 v126, v126, 3, v163
    ds_write_b64 v126, v[144:145] offset:33792
    v_subrev_u32 v157, 32, v157
    v_min_u32 v127, 32, v157
    v_lshl_add_u32 v127, v127, 3, v164
    ds_write_b64 v127, v[146:147] offset:33792
    v_subrev_u32 v158, 32, v158
    v_min_u32 v128, 32, v158
    v_lshl_add_u32 v128, v128, 3, v165
    ds_write_b64 v128, v[148:149] offset:33792
    v_subrev_u32 v159, 32, v159
    v_min_u32 v129, 32, v159
    v_lshl_add_u32 v129, v129, 3, v166
    ds_write_b64 v129, v[150:151] offset:33792
    v_subrev_u32 v160, 32, v160
    v_min_u32 v130, 32, v160
    v_lshl_add_u32 v130, v130, 3, v167
    s_mov_b64 exec, s[100:101]
    ds_write_b64 v130, v[152:153] offset:33792
    s_mov_b64 exec, -1
    s_add_u32 s57, s57, 16842752
    s_branch K2_PASS
K2_PR:
    s_sub_u32 s31, s31, 1
    s_cbranch_scc1 K2_TO
    s_mov_b64 exec, vcc
    buffer_load_dwordx4 v[136:139], v196, s[12:15], s50 offen sc1
    buffer_load_dwordx4 v[140:143], v196, s[12:15], s51 offen sc1
    buffer_load_dwordx4 v[144:147], v196, s[12:15], s52 offen sc1
    buffer_load_dwordx4 v[148:151], v196, s[12:15], s53 offen sc1
    s_waitcnt vmcnt(0)
    s_branch K2_PV
K2_TO:
    s_mov_b64 exec, 1
    v_mov_b32 v242, 0x9e377000
    buffer_atomic_add v242, v14, s[12:15], 0 offen sc1
    s_mov_b64 exec, -1
    s_mov_b64 s[42:43], 0
    s_mov_b64 s[44:45], 0
    s_mov_b64 s[46:47], 0
    s_mov_b64 s[48:49], 0
    ds_write_b32 v199, v14 offset:256
    s_mov_b64 s[100:101], 0
    s_branch K2_X7
K2_TG:
    s_mov_b64 exec, s[42:43]
    buffer_load_dwordx4 v[152:155], v196, s[12:15], s50 offen sc1
    s_mov_b64 exec, s[44:45]
    buffer_load_dwordx4 v[156:159], v196, s[12:15], s51 offen sc1
    s_mov_b64 exec, s[46:47]
    buffer_load_dwordx4 v[160:163], v196, s[12:15], s52 offen sc1
    s_mov_b64 exec, s[48:49]
    buffer_load_dwordx4 v[164:167], v196, s[12:15], s53 offen sc1
    s_mov_b64 exec, -1
    s_mov_b32 s30, 0
    s_branch K2_TGR
K2_TV:
    v_mfma_f32_32x32x16_bf16 v[104:119], v[168:171], v[184:187], 0
    v_mov_b32 v197, 0
    v_bitop3_b32 v136, v153, v155, s94 bitop3:0x7e
    v_bitop3_b32 v137, v157, v159, s94 bitop3:0x7e
    v_bitop3_b32 v138, v161, v163, s94 bitop3:0x7e
    v_bitop3_b32 v139, v165, v167, s94 bitop3:0x7e
    v_mfma_f32_32x32x16_bf16 v[120:135], v[168:171], v[188:191], 0
    v_cndmask_b32 v136, 0, v136, s[42:43]
    v_cndmask_b32 v137, 0, v137, s[44:45]
    v_cndmask_b32 v138, 0, v138, s[46:47]
    v_cndmask_b32 v139, 0, v139, s[48:49]
    v_or3_b32 v136, v136, v137, v138
    v_or_b32 v136, v136, v139
    v_cmp_lt_u32 vcc, s57, v136
    s_cbranch_vccnz K2_TR
    s_mov_b64 exec, s[42:43]
    v_bfe_u32 v136, v152, 1, 6
    v_lshl_add_u32 v136, v136, 2, v199
    ds_add_rtn_u32 v144, v136, v198
    v_bfe_u32 v137, v154, 1, 6
    v_lshl_add_u32 v137, v137, 2, v199
    ds_add_rtn_u32 v145, v137, v198
    v_or_b32 v197, v197, v152
    s_mov_b64 exec, s[44:45]
    v_bfe_u32 v138, v156, 1, 6
    v_lshl_add_u32 v138, v138, 2, v199
    ds_add_rtn_u32 v146, v138, v198
    v_bfe_u32 v139, v158, 1, 6
    v_lshl_add_u32 v139, v139, 2, v199
    ds_add_rtn_u32 v147, v139, v198
    v_or_b32 v197, v197, v156
    s_mov_b64 exec, s[46:47]
    v_bfe_u32 v140, v160, 1, 6
    v_lshl_add_u32 v140, v140, 2, v199
    ds_add_rtn_u32 v148, v140, v198
    v_bfe_u32 v141, v162, 1, 6
    v_lshl_add_u32 v141, v141, 2, v199
    ds_add_rtn_u32 v149, v141, v198
    v_or_b32 v197, v197, v160
    s_mov_b64 exec, s[48:49]
    v_bfe_u32 v142, v164, 1, 6
    v_lshl_add_u32 v142, v142, 2, v199
    ds_add_rtn_u32 v150, v142, v198
    v_bfe_u32 v143, v166, 1, 6
    v_lshl_add_u32 v143, v143, 2, v199
    ds_add_rtn_u32 v151, v143, v198
    v_or_b32 v197, v197, v164
    s_mov_b64 exec, -1
    v_lshl_add_u32 v153, v153, 5, v192
    v_lshl_add_u32 v155, v155, 5, v192
    v_lshl_add_u32 v157, v157, 5, v193
    v_lshl_add_u32 v159, v159, 5, v193
    v_lshl_add_u32 v161, v161, 5, v194
    v_lshl_add_u32 v163, v163, 5, v194
    v_lshl_add_u32 v165, v165, 5, v195
    v_lshl_add_u32 v167, v167, 5, v195
    v_cmp_lt_u32_sdwa vcc, s40, v197 src0_sel:DWORD src1_sel:BYTE_2
    s_waitcnt lgkmcnt(0)
    s_mov_b64 exec, s[42:43]
    v_min_u32 v144, s56, v144
    ds_write2st64_b32 v144, v152, v153 offset0:0 offset1:87
    v_min_u32 v145, s56, v145
    ds_write2st64_b32 v145, v154, v155 offset0:0 offset1:87
    s_mov_b64 exec, s[44:45]
    v_min_u32 v146, s56, v146
    ds_write2st64_b32 v146, v156, v157 offset0:0 offset1:87
    v_min_u32 v147, s56, v147
    ds_write2st64_b32 v147, v158, v159 offset0:0 offset1:87
    s_mov_b64 exec, s[46:47]
    v_min_u32 v148, s56, v148
    ds_write2st64_b32 v148, v160, v161 offset0:0 offset1:87
    v_min_u32 v149, s56, v149
    ds_write2st64_b32 v149, v162, v163 offset0:0 offset1:87
    s_mov_b64 exec, s[48:49]
    v_min_u32 v150, s56, v150
    ds_write2st64_b32 v150, v164, v165 offset0:0 offset1:87
    v_min_u32 v151, s56, v151
    ds_write2st64_b32 v151, v166, v167 offset0:0 offset1:87
    s_mov_b64 exec, -1
    s_cbranch_vccnz K2_TN
    s_branch K2_B3
K2_TM:
    v_mov_b32 v156, v152
    v_mov_b32 v160, v152
    v_mov_b32 v164, v152
K2_TN:
    s_add_u32 s28, s28, 1
    s_cmp_ge_u32 s28, 3
    s_cbranch_scc1 K2_OV
    s_mov_b64 exec, s[42:43]
    v_cmp_lt_u32_sdwa s[42:43], s40, v152 src0_sel:DWORD src1_sel:BYTE_2
    s_add_u32 s50, s50, 8421376
    s_mov_b64 exec, s[44:45]
    v_cmp_lt_u32_sdwa s[44:45], s40, v156 src0_sel:DWORD src1_sel:BYTE_2
    s_add_u32 s51, s51, 8421376
    s_mov_b64 exec, s[46:47]
    v_cmp_lt_u32_sdwa s[46:47], s40, v160 src0_sel:DWORD src1_sel:BYTE_2
    s_add_u32 s52, s52, 8421376
    s_mov_b64 exec, s[48:49]
    v_cmp_lt_u32_sdwa s[48:49], s40, v164 src0_sel:DWORD src1_sel:BYTE_2
    s_add_u32 s53, s53, 8421376
    s_waitcnt lgkmcnt(0)
K2_TR:
    s_sub_u32 s31, s31, 1
    s_cbranch_scc1 K2_OV
    s_mov_b64 exec, s[42:43]
    buffer_load_dwordx4 v[152:155], v196, s[12:15], s50 offen sc1
    s_mov_b64 exec, s[44:45]
    buffer_load_dwordx4 v[156:159], v196, s[12:15], s51 offen sc1
    s_mov_b64 exec, s[46:47]
    buffer_load_dwordx4 v[160:163], v196, s[12:15], s52 offen sc1
    s_mov_b64 exec, s[48:49]
    buffer_load_dwordx4 v[164:167], v196, s[12:15], s53 offen sc1
    s_mov_b64 exec, -1
    s_waitcnt vmcnt(0)
    s_branch K2_TV
K2_OV:
    s_mov_b64 exec, -1
    ds_write_b32 v199, v14 offset:256
    v_mfma_f32_32x32x16_bf16 v[104:119], v[168:171], v[184:187], 0
    v_mfma_f32_32x32x16_bf16 v[120:135], v[168:171], v[188:191], 0
    s_branch K2_B3
K2_FB:
    s_mov_b32 s32, 0
    s_mov_b32 s24, s37
    s_mov_b32 s29, 1
    s_branch K2_R1
K2_NEXT:
    s_mov_b32 s10, 6400000
    s_mov_b32 s6, 25600000
    s_waitcnt vmcnt(0) lgkmcnt(0)
    s_barrier
    v_mov_b32 v250, 128512
    v_lshl_add_u32 v251, v239, 2, v250
    v_mul_u32_u24 v252, 696, v239
    v_add_u32 v252, 43264, v252
    ds_write_b32 v251, v252
    v_add_u32 v252, 128, v252
    v_mov_b32 v192, 127
    v_mov_b32 v193, 4
    s_mov_b32 s45, 800000
    s_waitcnt lgkmcnt(0)
    s_barrier
K2_SCAN:
    v_add_u32 v254, s32, v0
    v_lshlrev_b32 v253, 2, v254
    buffer_load_dword v194, v253, s[96:99], 0 offen
    buffer_load_dword v195, v253, s[16:19], 0 offen
    v_cmp_gt_u32 s[46:47], s45, v254
    v_lshlrev_b32 v254, 5, v254
    s_add_u32 s32, s32, 512
    s_waitcnt vmcnt(0)
    v_mul_hi_u32 v196, v194, s33
    v_lshrrev_b32 v197, 3, v196
    v_cmp_eq_u32 vcc, s34, v197
    v_mad_u32_u24 v197, v196, s95, v192
    v_lshrrev_b32 v197, 7, v197
    v_sub_u32 v197, v194, v197
    v_and_b32 v196, 7, v196
    v_lshl_add_u32 v196, v196, 4, v250
    v_lshlrev_b32 v197, 27, v197
    v_lshl_or_b32 v197, v195, 7, v197
    s_and_b64 exec, vcc, s[46:47]
    ds_add_rtn_u32 v196, v196, v193 offset:128
    s_waitcnt lgkmcnt(0)
    ds_write2st64_b32 v196, v197, v254 offset0:0 offset1:87
    s_mov_b64 exec, -1
    s_waitcnt lgkmcnt(0)
    s_barrier
    ds_read_b32 v196, v251
    s_waitcnt lgkmcnt(0)
    s_barrier
    v_cmp_lt_u32 vcc, v252, v196
    s_cmp_ge_u32 s32, s45
    s_cbranch_scc1 K2_RN
    s_cbranch_vccz K2_SCAN
K2_RN:
    s_lshr_b32 s46, s39, 1
    s_add_u32 s46, s46, 32
    v_readlane_b32 s24, v196, s46
    v_and_b32 v7, 56, v239
    v_lshlrev_b32 v255, 2, v239
    v_and_b32 v8, 0x7c, v255
    v_add_u32 v7, s37, v7
    v_add_u32 v8, s37, v8
    v_add_u32 v192, s24, v255
    v_mov_b32 v193, 0xf87fff80
    v_mov_b32 v194, 0x1ffffe0
    s_sub_u32 s24, s24, s37
    s_add_u32 s24, s24, 127
    s_bfe_u32 s46, s24, 0x20005
    s_mov_b32 s47, 1.0
    s_lshr_b32 s24, s24, 7
    ds_write2st64_b32 v192, v193, v194 offset0:0 offset1:87
    ds_write2st64_b32 v192, v193, v194 offset0:1 offset1:88
    s_branch K2_G0
K2_LAST:
.section .rodata,"a"
.p2align 6
.amdhsa_kernel gather_scatter__edge_featured_mpnn_egc__graph_kernel
  .amdhsa_next_free_vgpr 256
  .amdhsa_next_free_sgpr 102
  .amdhsa_accum_offset 256
  .amdhsa_group_segment_fixed_size 0
  .amdhsa_kernarg_size 80
  .amdhsa_user_sgpr_count 2
  .amdhsa_user_sgpr_kernarg_segment_ptr 1
  .amdhsa_system_sgpr_workgroup_id_x 1
  .amdhsa_float_denorm_mode_32 3
.end_amdhsa_kernel
```
